```python
import torch

def _softmax(x, axis=-1):
    return torch.softmax(x, dim=axis)
def _gelu(x):
    return torch.nn.functional.gelu(x, approximate="tanh")
def _silu(x):
    return torch.nn.functional.silu(x)
def _sigmoid(x):
    return torch.sigmoid(x)
def _layernorm(x, axis=-1, eps=1e-5):
    m = x.mean(dim=axis, keepdim=True)
    v = x.var(dim=axis, keepdim=True, unbiased=False)
    return (x - m) / torch.sqrt(v + eps)
def _scatter_add(tgt, idx, src, axis=0):
    return tgt.clone().index_add_(axis, idx, src)
def _segment_sum(src, seg, n):
    out = torch.zeros((n,) + src.shape[1:], dtype=src.dtype)
    return out.index_add_(0, seg, src)
def _pad(x, pw):
    flat = tuple(v for pair in reversed(pw) for v in pair)
    return torch.nn.functional.pad(x, flat)

kernel_name = 'gather_scatter__hybrid_graph_tf_nagphormer__graph'

def setup_inputs():

    _w = (lambda a: (lambda t: t.to(torch.bfloat16) if t.is_floating_point() else t)(torch.as_tensor(a)))
    N, deg, D = 25000, 32, 64
    E = N * deg
    src = (lambda lo, hi, *s: torch.randint(lo, hi, s))(0, N, E).to(torch.int64)
    dst = (lambda lo, hi, *s: torch.randint(lo, hi, s))(0, N, E).to(torch.int64)
    deg_cnt = torch.bincount(dst, minlength=N).to(float) + 1.0
    sc = 1.0 / D ** 0.5
    return {
        "x": _w((lambda *s: torch.randn(*s, dtype=torch.bfloat16) * 0.1)(N, D)),
        "src": _w(src),
        "dst": _w(dst),
        "deg_inv_sqrt": _w(1.0 / (lambda _x: torch.sqrt(torch.as_tensor(_x)))(deg_cnt)),
        "wq": _w((lambda *s: torch.randn(*s, dtype=torch.bfloat16) * 1.6)(D, D) * sc),
        "wk": _w((lambda *s: torch.randn(*s, dtype=torch.bfloat16) * 3.2)(D, D) * sc),
        "wv": _w((lambda *s: torch.randn(*s, dtype=torch.bfloat16) * 0.1)(D, D) * sc),
        "wo": _w((lambda *s: torch.randn(*s, dtype=torch.bfloat16) * 0.1)(D, D) * sc),
        "w_r": _w((lambda *s: torch.randn(*s, dtype=torch.bfloat16) * 0.1)(D)),
    }

def reference(x, src, dst, deg_inv_sqrt, wq, wk, wv, wo, w_r):
    N, D = x.shape[0], x.shape[1]
    K = 7
    h = x
    toks = [x]
    for _ in range(K):
        msg = h[src] * deg_inv_sqrt[src, None] * deg_inv_sqrt[dst, None]
        h = _segment_sum(msg, dst, N)
        toks.append(h)
    tok = torch.stack(toks, axis=1)
    t = _layernorm(tok, axis=-1)
    q   = torch.einsum('nkd,de->nke', t, wq)
    key = torch.einsum('nkd,de->nke', t, wk)
    v   = torch.einsum('nkd,de->nke', t, wv)
    scale = 1.0 / (D ** 0.5)
    attn = _softmax(torch.einsum('nkd,nld->nkl', q, key) * scale, axis=-1)
    o = torch.einsum('nkl,nld->nkd', attn, v)
    o = tok + torch.einsum('nkd,de->nke', o, wo)
    r = _layernorm(o, axis=-1)
    alpha = _softmax(torch.einsum('nkd,d->nk', r, w_r), axis=-1)
    return torch.einsum('nk,nkd->nd', alpha, o)
```

```asm
; @launch kernel=k1_kernel grid=(250,1,1) block=(1024,1,1) lds=65024
; @launch kernel=p_kernel grid=(251,1,1) block=(1024,1,1) lds=163840
.amdgcn_target "amdgcn-amd-amdhsa--gfx950"
.text
.globl k1_kernel
.p2align 8
.type k1_kernel,@function
k1_kernel:
    s_cmp_ge_u32 s2, 250
    s_cbranch_scc1 k1_kernel_end2
    s_cmp_ge_u32 s2, 125
    s_cbranch_scc1 k1_kernel_g0

    s_load_dwordx4 s[4:7], s[0:1], 8
    s_load_dwordx2 s[12:13], s[0:1], 88
    v_lshlrev_b32 v1, 4, v0
    s_mul_i32 s3, s2, 25600
    v_add_u32 v2, s3, v1
    v_mov_b32 v20, 0
    v_mov_b32 v21, 0
    v_mov_b32 v22, 0
    v_mov_b32 v23, 0
    v_cmp_gt_u32 vcc, 576, v0
    s_mov_b64 s[40:41], vcc
    v_cmp_gt_u32 vcc, 992, v0
    s_mov_b64 s[42:43], vcc
    v_cmp_gt_u32 vcc, 928, v0
    s_mov_b64 s[44:45], vcc
    s_mov_b32 s30, 16384
    s_waitcnt lgkmcnt(0)

    s_mov_b32 s16, s4
    s_mov_b32 s17, s5
    s_mov_b32 s18, 3200000
    s_mov_b32 s19, 0x20000
    s_mov_b32 s20, s6
    s_mov_b32 s21, s7
    s_mov_b32 s22, 3200000
    s_mov_b32 s23, 0x20000
    s_mov_b32 s24, s12
    s_mov_b32 s25, s13
    s_mov_b32 s26, 50331648
    s_mov_b32 s27, 0x20000
    buffer_load_dwordx4 v[4:7], v2, s[20:23], 0 offen
    buffer_load_dwordx4 v[8:11], v2, s[20:23], s30 offen
    buffer_load_dwordx4 v[12:15], v2, s[16:19], 0 offen
    buffer_load_dwordx4 v[16:19], v2, s[16:19], s30 offen

    ds_write_b128 v1, v[20:23] offset:0
    ds_write_b128 v1, v[20:23] offset:16384
    ds_write_b128 v1, v[20:23] offset:32768
    s_mov_b64 exec, s[42:43]
    ds_write_b128 v1, v[20:23] offset:49152
    s_mov_b64 exec, -1
    v_mov_b32 v24, 1
    v_mov_b32 v25, 63
    v_mov_b32 v26, 0x40000000
    s_waitcnt lgkmcnt(0)
    s_barrier
    s_waitcnt vmcnt(2)

    v_mul_u32_u24 v28, 5243, v4
    v_lshrrev_b32 v28, 19, v28
    v_mul_u32_u24 v36, 100, v28
    v_sub_u32 v36, v4, v36
    v_lshlrev_b32 v28, 2, v28
    ds_add_rtn_u32 v44, v28, v24 offset:64000

    v_mul_u32_u24 v29, 5243, v5
    v_lshrrev_b32 v29, 19, v29
    v_mul_u32_u24 v37, 100, v29
    v_sub_u32 v37, v5, v37
    v_lshlrev_b32 v29, 2, v29
    ds_add_rtn_u32 v45, v29, v24 offset:64000

    v_mul_u32_u24 v30, 5243, v6
    v_lshrrev_b32 v30, 19, v30
    v_mul_u32_u24 v38, 100, v30
    v_sub_u32 v38, v6, v38
    v_lshlrev_b32 v30, 2, v30
    ds_add_rtn_u32 v46, v30, v24 offset:64000

    v_mul_u32_u24 v31, 5243, v7
    v_lshrrev_b32 v31, 19, v31
    v_mul_u32_u24 v39, 100, v31
    v_sub_u32 v39, v7, v39
    v_lshlrev_b32 v31, 2, v31
    ds_add_rtn_u32 v47, v31, v24 offset:64000

    s_mov_b64 exec, s[40:41]
    v_mul_u32_u24 v32, 5243, v8
    v_lshrrev_b32 v32, 19, v32
    v_mul_u32_u24 v40, 100, v32
    v_sub_u32 v40, v8, v40
    v_lshlrev_b32 v32, 2, v32
    ds_add_rtn_u32 v48, v32, v24 offset:64000

    v_mul_u32_u24 v33, 5243, v9
    v_lshrrev_b32 v33, 19, v33
    v_mul_u32_u24 v41, 100, v33
    v_sub_u32 v41, v9, v41
    v_lshlrev_b32 v33, 2, v33
    ds_add_rtn_u32 v49, v33, v24 offset:64000

    v_mul_u32_u24 v34, 5243, v10
    v_lshrrev_b32 v34, 19, v34
    v_mul_u32_u24 v42, 100, v34
    v_sub_u32 v42, v10, v42
    v_lshlrev_b32 v34, 2, v34
    ds_add_rtn_u32 v50, v34, v24 offset:64000

    v_mul_u32_u24 v35, 5243, v11
    v_lshrrev_b32 v35, 19, v35
    v_mul_u32_u24 v43, 100, v35
    v_sub_u32 v43, v11, v43
    v_lshlrev_b32 v35, 2, v35
    ds_add_rtn_u32 v51, v35, v24 offset:64000

    s_mov_b64 exec, -1
    s_waitcnt vmcnt(0)
    v_lshl_or_b32 v36, v36, 16, v12
    v_or_b32 v36, 0x80000000, v36
    v_lshl_or_b32 v37, v37, 16, v13
    v_or_b32 v37, 0x80000000, v37
    v_lshl_or_b32 v38, v38, 16, v14
    v_or_b32 v38, 0x80000000, v38
    v_lshl_or_b32 v39, v39, 16, v15
    v_or_b32 v39, 0x80000000, v39
    v_lshl_or_b32 v40, v40, 16, v16
    v_or_b32 v40, 0x80000000, v40
    v_lshl_or_b32 v41, v41, 16, v17
    v_or_b32 v41, 0x80000000, v41
    v_lshl_or_b32 v42, v42, 16, v18
    v_or_b32 v42, 0x80000000, v42
    v_lshl_or_b32 v43, v43, 16, v19
    v_or_b32 v43, 0x80000000, v43
    s_waitcnt lgkmcnt(0)
    v_cmp_gt_u32 vcc, 63, v44
    s_nop 1
    v_cndmask_b32 v36, v26, v36, vcc
    v_min_u32 v44, 63, v44
    v_lshlrev_b32 v28, 6, v28
    v_lshl_add_u32 v28, v44, 2, v28
    ds_write_b32 v28, v36

    v_cmp_gt_u32 vcc, 63, v45
    s_nop 1
    v_cndmask_b32 v37, v26, v37, vcc
    v_min_u32 v45, 63, v45
    v_lshlrev_b32 v29, 6, v29
    v_lshl_add_u32 v29, v45, 2, v29
    ds_write_b32 v29, v37

    v_cmp_gt_u32 vcc, 63, v46
    s_nop 1
    v_cndmask_b32 v38, v26, v38, vcc
    v_min_u32 v46, 63, v46
    v_lshlrev_b32 v30, 6, v30
    v_lshl_add_u32 v30, v46, 2, v30
    ds_write_b32 v30, v38

    v_cmp_gt_u32 vcc, 63, v47
    s_nop 1
    v_cndmask_b32 v39, v26, v39, vcc
    v_min_u32 v47, 63, v47
    v_lshlrev_b32 v31, 6, v31
    v_lshl_add_u32 v31, v47, 2, v31
    ds_write_b32 v31, v39

    s_mov_b64 exec, s[40:41]
    v_cmp_gt_u32 vcc, 63, v48
    s_nop 1
    v_cndmask_b32 v40, v26, v40, vcc
    v_min_u32 v48, 63, v48
    v_lshlrev_b32 v32, 6, v32
    v_lshl_add_u32 v32, v48, 2, v32
    ds_write_b32 v32, v40

    v_cmp_gt_u32 vcc, 63, v49
    s_nop 1
    v_cndmask_b32 v41, v26, v41, vcc
    v_min_u32 v49, 63, v49
    v_lshlrev_b32 v33, 6, v33
    v_lshl_add_u32 v33, v49, 2, v33
    ds_write_b32 v33, v41

    v_cmp_gt_u32 vcc, 63, v50
    s_nop 1
    v_cndmask_b32 v42, v26, v42, vcc
    v_min_u32 v50, 63, v50
    v_lshlrev_b32 v34, 6, v34
    v_lshl_add_u32 v34, v50, 2, v34
    ds_write_b32 v34, v42

    v_cmp_gt_u32 vcc, 63, v51
    s_nop 1
    v_cndmask_b32 v43, v26, v43, vcc
    v_min_u32 v51, 63, v51
    v_lshlrev_b32 v35, 6, v35
    v_lshl_add_u32 v35, v51, 2, v35
    ds_write_b32 v35, v43

    s_mov_b64 exec, -1
    v_lshrrev_b32 v52, 4, v0
    v_mul_u32_u24 v52, 32000, v52
    v_and_b32 v53, 15, v0
    v_lshl_add_u32 v52, v53, 4, v52
    s_lshl_b32 s31, s2, 8
    s_waitcnt lgkmcnt(0)
    s_barrier
    ds_read_b128 v[4:7], v1 offset:0
    ds_read_b128 v[8:11], v1 offset:16384
    ds_read_b128 v[12:15], v1 offset:32768
    ds_read_b128 v[16:19], v1 offset:49152
    s_waitcnt lgkmcnt(3)
    buffer_store_dwordx4 v[4:7], v52, s[24:27], s31 offen
    s_add_u32 s31, s31, 2048000
    s_waitcnt lgkmcnt(2)
    buffer_store_dwordx4 v[8:11], v52, s[24:27], s31 offen
    s_add_u32 s31, s31, 2048000
    s_waitcnt lgkmcnt(1)
    buffer_store_dwordx4 v[12:15], v52, s[24:27], s31 offen
    s_add_u32 s31, s31, 2048000
    s_mov_b64 exec, s[44:45]
    s_waitcnt lgkmcnt(0)
    buffer_store_dwordx4 v[16:19], v52, s[24:27], s31 offen
    s_branch k1_kernel_end

k1_kernel_g0:
    s_load_dwordx2 s[4:5], s[0:1], 0
    s_load_dwordx2 s[10:11], s[0:1], 24
    s_load_dwordx2 s[12:13], s[0:1], 88
    s_sub_u32 s3, s2, 125
    v_lshlrev_b32 v1, 4, v0
    s_mul_i32 s14, s3, 25600
    v_add_u32 v2, s14, v1
    s_mul_i32 s15, s3, 400
    v_lshrrev_b32 v3, 3, v0
    v_lshlrev_b32 v3, 1, v3
    v_add_u32 v3, s15, v3
    v_cmp_gt_u32 vcc, 576, v0
    s_mov_b64 s[40:41], vcc
    s_mov_b32 s38, 16384
    s_mov_b32 s36, 16777216
    s_mov_b32 s37, 16793600
    s_waitcnt lgkmcnt(0)

    s_mov_b32 s16, s4
    s_mov_b32 s17, s5
    s_mov_b32 s18, 3200000
    s_mov_b32 s19, 0x20000
    s_mov_b32 s28, s10
    s_mov_b32 s29, s11
    s_mov_b32 s30, 50000
    s_mov_b32 s31, 0x20000
    s_mov_b32 s32, s12
    s_mov_b32 s33, s13
    s_mov_b32 s34, 50331648
    s_mov_b32 s35, 0x20000
    buffer_load_dwordx4 v[4:7], v2, s[16:19], 0 offen
    buffer_load_ushort v16, v3, s[28:31], 0 offen
    buffer_load_dwordx4 v[8:11], v2, s[16:19], s38 offen
    buffer_load_ushort v17, v3, s[28:31], 0 offen offset:256

    s_cmp_lg_u32 s2, 125
    s_cbranch_scc1 k1_kernel_nofl
    v_mov_b32 v52, 0
    v_mov_b32 v53, 0
    v_mov_b32 v54, 0
    v_mov_b32 v55, 0
    v_mov_b32 v50, 255
    v_mov_b32 v51, 497
    v_cmp_eq_u32 vcc, v51, v0
    s_nop 1
    v_cndmask_b32 v52, 0, v50, vcc
    v_cndmask_b32 v53, 0, v50, vcc
    v_mov_b32 v51, 496
    v_cmp_eq_u32 s[46:47], v51, v0
    s_or_b64 vcc, vcc, s[46:47]
    v_cndmask_b32 v54, 0, v50, vcc
    v_cndmask_b32 v55, 0, v50, vcc
    v_lshlrev_b32 v50, 4, v0
    v_mov_b32 v51, 2147483632
    s_movk_i32 s39, 513
    v_cmp_gt_u32 vcc, s39, v0
    s_nop 1
    v_cndmask_b32 v50, v51, v50, vcc
    s_mov_b32 s39, 13631488
    buffer_store_dwordx4 v[52:55], v50, s[32:35], s39 offen
    s_waitcnt vmcnt(0)

k1_kernel_nofl:
    s_waitcnt vmcnt(2)
    v_lshlrev_b32 v16, 16, v16
    v_lshlrev_b32 v20, 16, v4
    v_and_b32 v24, 0xffff0000, v4
    v_mul_f32 v20, v20, v16
    v_mul_f32 v24, v24, v16

    v_lshlrev_b32 v21, 16, v5
    v_and_b32 v25, 0xffff0000, v5
    v_mul_f32 v21, v21, v16
    v_mul_f32 v25, v25, v16

    v_lshlrev_b32 v22, 16, v6
    v_and_b32 v26, 0xffff0000, v6
    v_mul_f32 v22, v22, v16
    v_mul_f32 v26, v26, v16

    v_lshlrev_b32 v23, 16, v7
    v_and_b32 v27, 0xffff0000, v7
    v_mul_f32 v23, v23, v16
    v_mul_f32 v27, v27, v16

    v_cvt_pk_bf16_f32 v36, v20, v21
    v_cvt_pk_bf16_f32 v37, v22, v23
    v_cvt_pk_bf16_f32 v38, v24, v25
    v_cvt_pk_bf16_f32 v39, v26, v27
    v_min_u32 v36, 0xfffffffe, v36

    buffer_store_dwordx4 v[36:39], v2, s[32:35], s36 offen
    s_waitcnt vmcnt(1)
    v_lshlrev_b32 v17, 16, v17
    v_lshlrev_b32 v20, 16, v8
    v_and_b32 v24, 0xffff0000, v8
    v_mul_f32 v20, v20, v17
    v_mul_f32 v24, v24, v17

    v_lshlrev_b32 v21, 16, v9
    v_and_b32 v25, 0xffff0000, v9
    v_mul_f32 v21, v21, v17
    v_mul_f32 v25, v25, v17

    v_lshlrev_b32 v22, 16, v10
    v_and_b32 v26, 0xffff0000, v10
    v_mul_f32 v22, v22, v17
    v_mul_f32 v26, v26, v17

    v_lshlrev_b32 v23, 16, v11
    v_and_b32 v27, 0xffff0000, v11
    v_mul_f32 v23, v23, v17
    v_mul_f32 v27, v27, v17

    v_cvt_pk_bf16_f32 v40, v20, v21
    v_cvt_pk_bf16_f32 v41, v22, v23
    v_cvt_pk_bf16_f32 v42, v24, v25
    v_cvt_pk_bf16_f32 v43, v26, v27
    v_min_u32 v40, 0xfffffffe, v40

    s_mov_b64 exec, s[40:41]
    buffer_store_dwordx4 v[40:43], v2, s[32:35], s37 offen
k1_kernel_end:
k1_kernel_end2:
    s_endpgm
.globl p_kernel
.p2align 8
.type p_kernel,@function
p_kernel:
    s_cmp_gt_u32 s2, 250
    s_cbranch_scc1 p_kernel_end
    s_cmp_eq_u32 s2, 250
    s_cbranch_scc1 p_kernel_prep
    s_load_dwordx2 s[10:11], s[0:1], 88
    s_load_dwordx4 s[4:7], s[0:1], 8
    s_load_dwordx2 s[8:9], s[0:1], 24
    s_load_dwordx2 s[46:47], s[0:1], 0
    s_load_dwordx4 s[88:91], s[0:1], 72
    v_mov_b32 v96, v0
    v_and_b32 v0, 63, v0
    v_lshrrev_b32 v64, 6, v96
    s_nop 0
    v_readfirstlane_b32 s3, v64
    v_lshlrev_b32 v65, 4, v96
    v_mov_b32 v73, 2147483632
    v_cmp_gt_u32 vcc, 976, v96
    s_nop 1
    v_cndmask_b32 v66, v73, v65, vcc
    s_mul_i32 s44, s2, 100
    s_mul_i32 s48, s2, 32000
    s_add_u32 s49, s48, 16384
    s_mul_i32 s51, s2, 12800
    v_add_u32 v125, s51, v65
    v_cmp_gt_u32 vcc, 800, v96
    s_nop 1
    v_cndmask_b32 v125, v73, v125, vcc
    v_add_u32 v72, s44, v96
    v_lshlrev_b32 v72, 1, v72
    v_mov_b32 v124, 1
    v_mov_b32 v60, -1
    v_mov_b32 v61, -1
    v_mov_b32 v62, -1
    v_mov_b32 v63, -1
    s_mov_b32 s66, 200000
    s_mov_b32 s70, 0x3f803f80
    s_waitcnt lgkmcnt(0)

    s_mov_b32 s12, s10
    s_mov_b32 s13, s11
    s_mov_b32 s14, 50331648
    s_mov_b32 s15, 0x20000
    buffer_load_dwordx4 v[100:103], v65, s[12:15], s48 offen
    buffer_load_dwordx4 v[104:107], v66, s[12:15], s49 offen

    s_mov_b32 s16, s46
    s_mov_b32 s17, s47
    s_mov_b32 s18, 3200000
    s_mov_b32 s19, 0x20000
    s_mov_b32 s20, s8
    s_mov_b32 s21, s9
    s_mov_b32 s22, 50000
    s_mov_b32 s23, 0x20000
    buffer_load_dwordx4 v[56:59], v125, s[16:19], 0 offen
    buffer_load_ushort v99, v72, s[20:23], 0 offen

    s_mov_b32 s24, s4
    s_mov_b32 s25, s5
    s_mov_b32 s26, 3200000
    s_mov_b32 s27, 0x20000
    s_mov_b32 s28, s6
    s_mov_b32 s29, s7
    s_mov_b32 s30, 3200000
    s_mov_b32 s31, 0x20000
    s_add_u32 s32, s10, 16777216
    s_addc_u32 s33, s11, 0
    s_mov_b32 s34, 3200000
    s_mov_b32 s35, 0x20000
    s_mov_b32 s36, s88
    s_mov_b32 s37, s89
    s_mov_b32 s38, 3200000
    s_mov_b32 s39, 0x20000
    s_add_u32 s40, s10, 20971520
    s_addc_u32 s41, s11, 0
    s_mov_b32 s42, 3200000
    s_mov_b32 s43, 0x20000
    s_mov_b32 s92, s90
    s_mov_b32 s93, s91
    s_mov_b32 s94, 256
    s_mov_b32 s95, 0x20000
    v_mov_b32 v68, -1
    v_mov_b32 v69, -1
    v_mov_b32 v70, -1
    v_mov_b32 v71, -1
    v_add_u32 v66, 102400, v65
    v_cmp_gt_u32 vcc, 832, v96
    s_and_saveexec_b64 s[60:61], vcc
    ds_write_b128 v66, v[68:71]
    s_mov_b64 exec, s[60:61]
    v_mov_b32 v76, 0
    v_mov_b32 v77, 0
    v_mov_b32 v78, 0
    v_mov_b32 v79, 0
    v_add_u32 v66, 138240, v65
    v_cmp_gt_u32 vcc, 577, v96
    s_and_saveexec_b64 s[60:61], vcc
    ds_write_b128 v66, v[76:79]
    s_mov_b64 exec, s[60:61]
    v_lshlrev_b32 v66, 2, v96
    v_add_u32 v66, 137792, v66
    v_cmp_gt_u32 vcc, 16, v96
    s_and_saveexec_b64 s[60:61], vcc
    ds_write_b32 v66, v76
    s_mov_b64 exec, s[60:61]
    s_mov_b32 s53, 10737
    s_mov_b32 s54, 138240
    s_mov_b32 s55, 146432
    s_waitcnt lgkmcnt(0)
    s_barrier
    s_cmp_lt_u32 s3, 13
    s_cbranch_scc1 p_kernel_w0
    s_waitcnt vmcnt(2)
    s_branch p_kernel_w1

p_kernel_w0:
    s_waitcnt vmcnt(2)
p_kernel_w1:
    s_mov_b32 s62, 20971520
    buffer_store_dwordx4 v[60:63], v125, s[12:15], s62 offen sc1
    s_mov_b32 s62, 25165824
    buffer_store_dwordx4 v[60:63], v125, s[12:15], s62 offen sc1
    s_mov_b32 s62, 29360128
    buffer_store_dwordx4 v[60:63], v125, s[12:15], s62 offen sc1
    v_or3_b32 v64, v100, v101, v102
    v_or3_b32 v64, v64, v103, v104
    v_or3_b32 v64, v64, v105, v106
    v_or_b32 v64, v64, v107
    v_and_b32 v64, 0x40000000, v64
    v_cmp_ne_u32 vcc, 0, v64
    s_and_saveexec_b64 s[60:61], vcc
    v_mov_b32 v65, 147456
    ds_write_b32 v65, v124
    s_mov_b64 exec, s[60:61]

    v_cmp_gt_i32 s[72:73], 0, v100
    v_mad_u32_u16 v66, v100, s53, 0
    v_bfe_u32 v67, v100, 16, 7
    v_lshrrev_b32 v66, 22, v66
    v_and_or_b32 v66, v66, 60, s54
    v_lshl_add_u32 v108, v67, 6, v66
    v_lshl_add_u32 v67, v67, 2, s55
    s_mov_b64 exec, s[72:73]
    ds_add_rtn_u32 v116, v108, v124
    ds_add_u32 v67, v124
    s_mov_b64 exec, -1

    v_cmp_gt_i32 s[74:75], 0, v101
    v_mad_u32_u16 v66, v101, s53, 0
    v_bfe_u32 v67, v101, 16, 7
    v_lshrrev_b32 v66, 22, v66
    v_and_or_b32 v66, v66, 60, s54
    v_lshl_add_u32 v109, v67, 6, v66
    v_lshl_add_u32 v67, v67, 2, s55
    s_mov_b64 exec, s[74:75]
    ds_add_rtn_u32 v117, v109, v124
    ds_add_u32 v67, v124
    s_mov_b64 exec, -1

    v_cmp_gt_i32 s[76:77], 0, v102
    v_mad_u32_u16 v66, v102, s53, 0
    v_bfe_u32 v67, v102, 16, 7
    v_lshrrev_b32 v66, 22, v66
    v_and_or_b32 v66, v66, 60, s54
    v_lshl_add_u32 v110, v67, 6, v66
    v_lshl_add_u32 v67, v67, 2, s55
    s_mov_b64 exec, s[76:77]
    ds_add_rtn_u32 v118, v110, v124
    ds_add_u32 v67, v124
    s_mov_b64 exec, -1

    v_cmp_gt_i32 s[78:79], 0, v103
    v_mad_u32_u16 v66, v103, s53, 0
    v_bfe_u32 v67, v103, 16, 7
    v_lshrrev_b32 v66, 22, v66
    v_and_or_b32 v66, v66, 60, s54
    v_lshl_add_u32 v111, v67, 6, v66
    v_lshl_add_u32 v67, v67, 2, s55
    s_mov_b64 exec, s[78:79]
    ds_add_rtn_u32 v119, v111, v124
    ds_add_u32 v67, v124
    s_mov_b64 exec, -1

    v_cmp_gt_i32 s[80:81], 0, v104
    v_mad_u32_u16 v66, v104, s53, 0
    v_bfe_u32 v67, v104, 16, 7
    v_lshrrev_b32 v66, 22, v66
    v_and_or_b32 v66, v66, 60, s54
    v_lshl_add_u32 v112, v67, 6, v66
    v_lshl_add_u32 v67, v67, 2, s55
    s_mov_b64 exec, s[80:81]
    ds_add_rtn_u32 v120, v112, v124
    ds_add_u32 v67, v124
    s_mov_b64 exec, -1

    v_cmp_gt_i32 s[82:83], 0, v105
    v_mad_u32_u16 v66, v105, s53, 0
    v_bfe_u32 v67, v105, 16, 7
    v_lshrrev_b32 v66, 22, v66
    v_and_or_b32 v66, v66, 60, s54
    v_lshl_add_u32 v113, v67, 6, v66
    v_lshl_add_u32 v67, v67, 2, s55
    s_mov_b64 exec, s[82:83]
    ds_add_rtn_u32 v121, v113, v124
    ds_add_u32 v67, v124
    s_mov_b64 exec, -1

    v_cmp_gt_i32 s[84:85], 0, v106
    v_mad_u32_u16 v66, v106, s53, 0
    v_bfe_u32 v67, v106, 16, 7
    v_lshrrev_b32 v66, 22, v66
    v_and_or_b32 v66, v66, 60, s54
    v_lshl_add_u32 v114, v67, 6, v66
    v_lshl_add_u32 v67, v67, 2, s55
    s_mov_b64 exec, s[84:85]
    ds_add_rtn_u32 v122, v114, v124
    ds_add_u32 v67, v124
    s_mov_b64 exec, -1

    v_cmp_gt_i32 s[86:87], 0, v107
    v_mad_u32_u16 v66, v107, s53, 0
    v_bfe_u32 v67, v107, 16, 7
    v_lshrrev_b32 v66, 22, v66
    v_and_or_b32 v66, v66, 60, s54
    v_lshl_add_u32 v115, v67, 6, v66
    v_lshl_add_u32 v67, v67, 2, s55
    s_mov_b64 exec, s[86:87]
    ds_add_rtn_u32 v123, v115, v124
    ds_add_u32 v67, v124
    s_mov_b64 exec, -1

    s_waitcnt lgkmcnt(0)
    s_barrier

    s_mov_b32 s62, 33554432
    buffer_store_dwordx4 v[60:63], v125, s[12:15], s62 offen sc1
    s_mov_b32 s62, 37748736
    buffer_store_dwordx4 v[60:63], v125, s[12:15], s62 offen sc1
    s_mov_b32 s62, 41943040
    buffer_store_dwordx4 v[60:63], v125, s[12:15], s62 offen sc1
    v_and_b32 v64, 127, v96
    v_lshlrev_b32 v65, 2, v64
    v_add_u32 v65, 146432, v65
    ds_read_b32 v98, v65
    s_lshr_b32 s46, s3, 1
    s_lshl_b32 s47, s46, 6
    s_add_u32 s47, s47, 146432
    v_mov_b32 v66, s47

    ds_read_b128 v[68:71], v66 offset:0
    ds_read_b128 v[72:75], v66 offset:16
    ds_read_b128 v[76:79], v66 offset:32
    ds_read_b128 v[80:83], v66 offset:48
    s_cmp_gt_u32 s3, 1
    s_cbranch_scc1 p_kernel_nopx
    v_lshlrev_b32 v86, 6, v96
    v_add_u32 v86, 138240, v86

    ds_read_b128 v[24:27], v86 offset:0
    ds_read_b128 v[28:31], v86 offset:16
    ds_read_b128 v[32:35], v86 offset:32
    ds_read_b128 v[36:39], v86 offset:48
    s_waitcnt lgkmcnt(0)
    v_mov_b32 v40, 0
    v_add_u32 v41, v40, v24
    v_add_u32 v42, v41, v25
    v_add_u32 v43, v42, v26
    v_add_u32 v44, v43, v27
    v_add_u32 v45, v44, v28
    v_add_u32 v46, v45, v29
    v_add_u32 v47, v46, v30
    v_add_u32 v48, v47, v31
    v_add_u32 v49, v48, v32
    v_add_u32 v50, v49, v33
    v_add_u32 v51, v50, v34
    v_add_u32 v52, v51, v35
    v_add_u32 v53, v52, v36
    v_add_u32 v54, v53, v37
    v_add_u32 v55, v54, v38
    ds_write_b128 v86, v[40:43] offset:0
    ds_write_b128 v86, v[44:47] offset:16
    ds_write_b128 v86, v[48:51] offset:32
    ds_write_b128 v86, v[52:55] offset:48
p_kernel_nopx:
    s_lshl_b32 s47, s46, 4
    s_waitcnt lgkmcnt(0)
    v_lshlrev_b32 v67, 7, v98
    v_sub_u32 v67, v67, v64
    v_add_u32 v67, s47, v67
    v_mov_b32 v84, 0

    v_lshl_add_u32 v85, v68, 7, 0
    v_cmp_gt_i32 vcc, v85, v67
    s_nop 1
    v_addc_co_u32 v84, vcc, 0, v84, vcc

    v_lshl_add_u32 v85, v69, 7, -1
    v_cmp_gt_i32 vcc, v85, v67
    s_nop 1
    v_addc_co_u32 v84, vcc, 0, v84, vcc

    v_lshl_add_u32 v85, v70, 7, -2
    v_cmp_gt_i32 vcc, v85, v67
    s_nop 1
    v_addc_co_u32 v84, vcc, 0, v84, vcc

    v_lshl_add_u32 v85, v71, 7, -3
    v_cmp_gt_i32 vcc, v85, v67
    s_nop 1
    v_addc_co_u32 v84, vcc, 0, v84, vcc

    v_lshl_add_u32 v85, v72, 7, -4
    v_cmp_gt_i32 vcc, v85, v67
    s_nop 1
    v_addc_co_u32 v84, vcc, 0, v84, vcc

    v_lshl_add_u32 v85, v73, 7, -5
    v_cmp_gt_i32 vcc, v85, v67
    s_nop 1
    v_addc_co_u32 v84, vcc, 0, v84, vcc

    v_lshl_add_u32 v85, v74, 7, -6
    v_cmp_gt_i32 vcc, v85, v67
    s_nop 1
    v_addc_co_u32 v84, vcc, 0, v84, vcc

    v_lshl_add_u32 v85, v75, 7, -7
    v_cmp_gt_i32 vcc, v85, v67
    s_nop 1
    v_addc_co_u32 v84, vcc, 0, v84, vcc

    v_lshl_add_u32 v85, v76, 7, -8
    v_cmp_gt_i32 vcc, v85, v67
    s_nop 1
    v_addc_co_u32 v84, vcc, 0, v84, vcc

    v_lshl_add_u32 v85, v77, 7, -9
    v_cmp_gt_i32 vcc, v85, v67
    s_nop 1
    v_addc_co_u32 v84, vcc, 0, v84, vcc

    v_lshl_add_u32 v85, v78, 7, -10
    v_cmp_gt_i32 vcc, v85, v67
    s_nop 1
    v_addc_co_u32 v84, vcc, 0, v84, vcc

    v_lshl_add_u32 v85, v79, 7, -11
    v_cmp_gt_i32 vcc, v85, v67
    s_nop 1
    v_addc_co_u32 v84, vcc, 0, v84, vcc

    v_lshl_add_u32 v85, v80, 7, -12
    v_cmp_gt_i32 vcc, v85, v67
    s_nop 1
    v_addc_co_u32 v84, vcc, 0, v84, vcc

    v_lshl_add_u32 v85, v81, 7, -13
    v_cmp_gt_i32 vcc, v85, v67
    s_nop 1
    v_addc_co_u32 v84, vcc, 0, v84, vcc

    v_lshl_add_u32 v85, v82, 7, -14
    v_cmp_gt_i32 vcc, v85, v67
    s_nop 1
    v_addc_co_u32 v84, vcc, 0, v84, vcc

    v_lshl_add_u32 v85, v83, 7, -15
    v_cmp_gt_i32 vcc, v85, v67
    s_nop 1
    v_addc_co_u32 v84, vcc, 0, v84, vcc

    ds_add_u32 v65, v84 offset:512
    s_waitcnt lgkmcnt(0)
    s_barrier

    v_cmp_gt_u32 vcc, 100, v96
    s_mov_b64 s[48:49], vcc
    v_lshrrev_b32 v68, 3, v96
    v_lshlrev_b32 v68, 2, v68
    v_add_u32 v68, 146944, v68
    ds_read_b32 v126, v68
    s_mov_b64 exec, s[48:49]
    ds_read_b32 v97, v65 offset:512
    v_mov_b32 v67, 147472
    s_waitcnt lgkmcnt(0)
    v_lshl_add_u32 v66, v97, 2, v67
    ds_write_b32 v66, v98
    s_mov_b64 exec, -1
    s_waitcnt lgkmcnt(0)
    s_barrier

    s_mov_b32 s58, 0
    s_mov_b64 s[56:57], 0
    s_cmp_ge_u32 s3, 13
    s_cbranch_scc1 p_kernel_nopos
    s_lshl_b32 s46, s3, 4
    s_add_u32 s47, s46, 147472
    v_mov_b32 v64, s47
    s_sub_u32 s47, 147872, s46
    v_mov_b32 v65, s47
    ds_read_b32 v66, v64
    ds_read_b32 v67, v65
    v_cvt_f32_u32 v68, v0
    s_waitcnt lgkmcnt(0)
    v_readfirstlane_b32 s46, v66
    v_readfirstlane_b32 s47, v67
    s_add_u32 s46, s46, 1
    s_lshr_b32 s46, s46, 1
    s_add_u32 s47, s47, 1
    s_lshr_b32 s47, s47, 1
    s_cmp_eq_u32 s3, 0
    s_cselect_b32 s47, 0, s47
    s_add_u32 s59, s46, s47
    s_max_u32 s58, s59, 4
    s_sub_u32 s58, s58, 4
    v_cvt_f32_u32 v69, s47
    v_cvt_f32_u32 v70, s59
    v_rcp_f32 v71, v70
    v_fma_f32 v70, v70, 0.5, 0.5
    v_add_f32 v70, 0xbe800000, v70
    v_fma_f32 v72, v68, v69, v70
    v_add_f32 v73, v72, v69
    v_mul_f32 v72, v72, v71
    v_mul_f32 v73, v73, v71
    v_cvt_u32_f32 v72, v72
    v_cvt_u32_f32 v73, v73
    v_sub_u32 v74, v0, v72
    v_cmp_ne_u32 vcc, v72, v73
    s_nop 1
    v_cndmask_b32 v74, v74, v72, vcc
    v_cndmask_b32 v75, 0, 64, vcc
    v_cmp_gt_u32 s[60:61], s59, v0
    s_and_b64 s[56:57], vcc, s[60:61]
    s_lshl_b32 s46, s3, 7
    s_add_u32 s46, s46, 148496
    v_add3_u32 v74, v74, v75, s46
    s_mov_b64 exec, s[60:61]
    ds_write_b8 v74, v0
    s_mov_b64 exec, -1
    s_cmp_le_u32 s59, 64
    s_cbranch_scc1 p_kernel_nopos
    v_mov_b32 v65, 147456
    ds_write_b32 v65, v124

p_kernel_nopos:
    s_cmp_gt_u32 s3, 1
    s_cbranch_scc1 p_kernel_nohdr
    s_waitcnt vmcnt(6)
    s_mov_b64 exec, s[48:49]

    v_lshrrev_b32 v64, 2, v97
    v_and_b32 v65, 3, v97
    v_sub_u32 v70, 25, v64
    v_cmp_lt_u32 vcc, 12, v64
    s_nop 1
    v_cndmask_b32 v66, v64, v70, vcc
    v_cndmask_b32 v67, 0, v124, vcc

    v_lshrrev_b32 v70, 1, v65
    v_lshlrev_b32 v70, 6, v70
    v_and_b32 v71, 1, v65
    v_lshl_add_u32 v70, v71, 4, v70
    v_lshl_add_u32 v70, v66, 10, v70
    v_lshlrev_b32 v71, 7, v66
    v_lshl_add_u32 v71, v67, 6, v71
    v_lshl_or_b32 v70, v71, 16, v70
    v_lshlrev_b32 v71, 2, v96
    v_add_u32 v71, 147984, v71
    ds_write_b32 v71, v70

    v_add_u32 v70, s44, v96
    v_lshl_or_b32 v70, v99, 16, v70
    v_lshlrev_b32 v71, 5, v66
    v_lshl_add_u32 v71, v65, 3, v71
    v_add_u32 v71, 137344, v71
    v_lshl_add_u32 v76, v67, 2, v71
    ds_write_b32 v76, v70
    v_cmp_eq_u32 vcc, 0, v64
    s_and_saveexec_b64 s[60:61], vcc
    v_mov_b32 v70, 0xffff
    ds_write_b32 v71, v70 offset:4
    s_mov_b64 exec, s[60:61]

    s_mov_b64 exec, -1
p_kernel_nohdr:
    s_waitcnt lgkmcnt(0)
    s_barrier

    v_mov_b32 v64, 147456
    ds_read_b32 v65, v64
    s_mov_b32 s54, 147984
    s_mov_b32 s55, 148496
    s_mov_b32 s59, 102400

    v_bfe_u32 v67, v100, 16, 7
    v_lshl_add_u32 v67, v67, 2, s54
    ds_read_b32 v24, v108
    ds_read_b32 v32, v67

    v_bfe_u32 v67, v101, 16, 7
    v_lshl_add_u32 v67, v67, 2, s54
    ds_read_b32 v25, v109
    ds_read_b32 v33, v67

    v_bfe_u32 v67, v102, 16, 7
    v_lshl_add_u32 v67, v67, 2, s54
    ds_read_b32 v26, v110
    ds_read_b32 v34, v67

    v_bfe_u32 v67, v103, 16, 7
    v_lshl_add_u32 v67, v67, 2, s54
    ds_read_b32 v27, v111
    ds_read_b32 v35, v67

    v_bfe_u32 v67, v104, 16, 7
    v_lshl_add_u32 v67, v67, 2, s54
    ds_read_b32 v28, v112
    ds_read_b32 v36, v67

    v_bfe_u32 v67, v105, 16, 7
    v_lshl_add_u32 v67, v67, 2, s54
    ds_read_b32 v29, v113
    ds_read_b32 v37, v67

    v_bfe_u32 v67, v106, 16, 7
    v_lshl_add_u32 v67, v67, 2, s54
    ds_read_b32 v30, v114
    ds_read_b32 v38, v67

    v_bfe_u32 v67, v107, 16, 7
    v_lshl_add_u32 v67, v67, 2, s54
    ds_read_b32 v31, v115
    ds_read_b32 v39, v67

    s_waitcnt lgkmcnt(0)
    v_readfirstlane_b32 s50, v65
    s_cmp_lg_u32 s50, 0
    s_cbranch_scc1 p_kernel_slowsetup

    v_add_u32 v24, v24, v116
    v_lshrrev_b32 v67, 16, v32
    v_lshrrev_b32 v68, 1, v24
    v_add3_u32 v67, v67, v68, s55
    ds_read_u8 v40, v67
    v_and_b32 v32, 0xffff, v32
    v_and_b32 v24, 1, v24
    v_lshl_add_u32 v32, v24, 5, v32

    v_add_u32 v25, v25, v117
    v_lshrrev_b32 v67, 16, v33
    v_lshrrev_b32 v68, 1, v25
    v_add3_u32 v67, v67, v68, s55
    ds_read_u8 v41, v67
    v_and_b32 v33, 0xffff, v33
    v_and_b32 v25, 1, v25
    v_lshl_add_u32 v33, v25, 5, v33

    v_add_u32 v26, v26, v118
    v_lshrrev_b32 v67, 16, v34
    v_lshrrev_b32 v68, 1, v26
    v_add3_u32 v67, v67, v68, s55
    ds_read_u8 v42, v67
    v_and_b32 v34, 0xffff, v34
    v_and_b32 v26, 1, v26
    v_lshl_add_u32 v34, v26, 5, v34

    v_add_u32 v27, v27, v119
    v_lshrrev_b32 v67, 16, v35
    v_lshrrev_b32 v68, 1, v27
    v_add3_u32 v67, v67, v68, s55
    ds_read_u8 v43, v67
    v_and_b32 v35, 0xffff, v35
    v_and_b32 v27, 1, v27
    v_lshl_add_u32 v35, v27, 5, v35

    v_add_u32 v28, v28, v120
    v_lshrrev_b32 v67, 16, v36
    v_lshrrev_b32 v68, 1, v28
    v_add3_u32 v67, v67, v68, s55
    ds_read_u8 v44, v67
    v_and_b32 v36, 0xffff, v36
    v_and_b32 v28, 1, v28
    v_lshl_add_u32 v36, v28, 5, v36

    v_add_u32 v29, v29, v121
    v_lshrrev_b32 v67, 16, v37
    v_lshrrev_b32 v68, 1, v29
    v_add3_u32 v67, v67, v68, s55
    ds_read_u8 v45, v67
    v_and_b32 v37, 0xffff, v37
    v_and_b32 v29, 1, v29
    v_lshl_add_u32 v37, v29, 5, v37

    v_add_u32 v30, v30, v122
    v_lshrrev_b32 v67, 16, v38
    v_lshrrev_b32 v68, 1, v30
    v_add3_u32 v67, v67, v68, s55
    ds_read_u8 v46, v67
    v_and_b32 v38, 0xffff, v38
    v_and_b32 v30, 1, v30
    v_lshl_add_u32 v38, v30, 5, v38

    v_add_u32 v31, v31, v123
    v_lshrrev_b32 v67, 16, v39
    v_lshrrev_b32 v68, 1, v31
    v_add3_u32 v67, v67, v68, s55
    ds_read_u8 v47, v67
    v_and_b32 v39, 0xffff, v39
    v_and_b32 v31, 1, v31
    v_lshl_add_u32 v39, v31, 5, v39

    s_waitcnt lgkmcnt(0)
    v_lshrrev_b32 v67, 3, v40
    v_lshl_add_u32 v32, v67, 7, v32
    v_and_b32 v67, 7, v40
    v_lshlrev_b32 v67, 1, v67
    v_add3_u32 v32, v32, v67, s59
    s_mov_b64 exec, s[72:73]
    ds_write_b16 v32, v100
    s_mov_b64 exec, -1

    v_lshrrev_b32 v67, 3, v41
    v_lshl_add_u32 v33, v67, 7, v33
    v_and_b32 v67, 7, v41
    v_lshlrev_b32 v67, 1, v67
    v_add3_u32 v33, v33, v67, s59
    s_mov_b64 exec, s[74:75]
    ds_write_b16 v33, v101
    s_mov_b64 exec, -1

    v_lshrrev_b32 v67, 3, v42
    v_lshl_add_u32 v34, v67, 7, v34
    v_and_b32 v67, 7, v42
    v_lshlrev_b32 v67, 1, v67
    v_add3_u32 v34, v34, v67, s59
    s_mov_b64 exec, s[76:77]
    ds_write_b16 v34, v102
    s_mov_b64 exec, -1

    v_lshrrev_b32 v67, 3, v43
    v_lshl_add_u32 v35, v67, 7, v35
    v_and_b32 v67, 7, v43
    v_lshlrev_b32 v67, 1, v67
    v_add3_u32 v35, v35, v67, s59
    s_mov_b64 exec, s[78:79]
    ds_write_b16 v35, v103
    s_mov_b64 exec, -1

    v_lshrrev_b32 v67, 3, v44
    v_lshl_add_u32 v36, v67, 7, v36
    v_and_b32 v67, 7, v44
    v_lshlrev_b32 v67, 1, v67
    v_add3_u32 v36, v36, v67, s59
    s_mov_b64 exec, s[80:81]
    ds_write_b16 v36, v104
    s_mov_b64 exec, -1

    v_lshrrev_b32 v67, 3, v45
    v_lshl_add_u32 v37, v67, 7, v37
    v_and_b32 v67, 7, v45
    v_lshlrev_b32 v67, 1, v67
    v_add3_u32 v37, v37, v67, s59
    s_mov_b64 exec, s[82:83]
    ds_write_b16 v37, v105
    s_mov_b64 exec, -1

    v_lshrrev_b32 v67, 3, v46
    v_lshl_add_u32 v38, v67, 7, v38
    v_and_b32 v67, 7, v46
    v_lshlrev_b32 v67, 1, v67
    v_add3_u32 v38, v38, v67, s59
    s_mov_b64 exec, s[84:85]
    ds_write_b16 v38, v106
    s_mov_b64 exec, -1

    v_lshrrev_b32 v67, 3, v47
    v_lshl_add_u32 v39, v67, 7, v39
    v_and_b32 v67, 7, v47
    v_lshlrev_b32 v67, 1, v67
    v_add3_u32 v39, v39, v67, s59
    s_mov_b64 exec, s[86:87]
    ds_write_b16 v39, v107
    s_mov_b64 exec, -1

    s_branch p_kernel_built
p_kernel_slowsetup:
    v_lshrrev_b32 v126, 3, v96
    s_cmp_gt_u32 s3, 1
    s_cbranch_scc1 p_kernel_built
    s_mov_b64 exec, s[48:49]
    v_mov_b32 v97, v96

    v_lshrrev_b32 v64, 2, v97
    v_and_b32 v65, 3, v97
    v_sub_u32 v70, 25, v64
    v_cmp_lt_u32 vcc, 12, v64
    s_nop 1
    v_cndmask_b32 v66, v64, v70, vcc
    v_cndmask_b32 v67, 0, v124, vcc

    v_add_u32 v70, s44, v96
    v_lshl_or_b32 v70, v99, 16, v70
    v_lshlrev_b32 v71, 5, v66
    v_lshl_add_u32 v71, v65, 3, v71
    v_add_u32 v71, 137344, v71
    v_lshl_add_u32 v76, v67, 2, v71
    ds_write_b32 v76, v70
    v_cmp_eq_u32 vcc, 0, v64
    s_and_saveexec_b64 s[60:61], vcc
    v_mov_b32 v70, 0xffff
    ds_write_b32 v71, v70 offset:4
    s_mov_b64 exec, s[60:61]

    s_mov_b64 exec, -1
p_kernel_built:
    s_cmp_ge_u32 s3, 13
    s_cbranch_scc1 p_kernel_notok0
    s_waitcnt vmcnt(6)
    s_mov_b32 s62, 0x05040100
    s_mov_b32 s63, 0x07060302
    v_perm_b32 v84, v57, v56, s62
    v_perm_b32 v85, v59, v58, s62
    v_perm_b32 v86, v57, v56, s63
    v_perm_b32 v87, v59, v58, s63
    v_lshlrev_b32 v72, 10, v126
    v_and_b32 v73, 7, v96
    v_lshl_add_u32 v72, v73, 4, v72

    v_dot2_f32_bf16 v65, v84, s70, 0
    v_dot2_f32_bf16 v66, v84, v84, 0
    v_dot2_f32_bf16 v65, v85, s70, v65
    v_dot2_f32_bf16 v66, v85, v85, v66
    v_dot2_f32_bf16 v65, v86, s70, v65
    v_dot2_f32_bf16 v66, v86, v86, v66
    v_dot2_f32_bf16 v65, v87, s70, v65
    v_dot2_f32_bf16 v66, v87, v87, v66
    s_nop 1
    v_add_f32_dpp v65, v65, v65 quad_perm:[1,0,3,2] row_mask:0xf bank_mask:0xf
    v_add_f32_dpp v66, v66, v66 quad_perm:[1,0,3,2] row_mask:0xf bank_mask:0xf
    s_nop 0
    v_add_f32_dpp v65, v65, v65 quad_perm:[2,3,0,1] row_mask:0xf bank_mask:0xf
    v_add_f32_dpp v66, v66, v66 quad_perm:[2,3,0,1] row_mask:0xf bank_mask:0xf
    s_nop 0
    v_add_f32_dpp v65, v65, v65 row_half_mirror row_mask:0xf bank_mask:0xf
    v_add_f32_dpp v66, v66, v66 row_half_mirror row_mask:0xf bank_mask:0xf
    v_mul_f32 v65, 0x3c800000, v65
    v_mul_f32 v66, 0x3c800000, v66
    v_fma_f32 v67, -v65, v65, v66
    v_max_f32 v67, 0, v67
    v_add_f32 v67, 0x3727c5ac, v67
    v_rsq_f32 v64, v67

    v_lshlrev_b32 v73, 5, v126
    v_add_u32 v73, 134144, v73
    v_cmp_gt_u32 vcc, 800, v96
    s_and_saveexec_b64 s[60:61], vcc
    ds_write_b128 v72, v[84:87] offset:0
    ds_write_b32 v73, v64
    s_mov_b64 exec, s[60:61]

p_kernel_notok0:
    s_waitcnt vmcnt(0) lgkmcnt(0)
    s_barrier

    v_and_b32 v1, 7, v0
    v_lshlrev_b32 v1, 4, v1
    v_mov_b32 v2, 128
    v_and_b32 v64, 7, v0
    v_and_b32 v65, 1, v64
    v_lshlrev_b32 v65, 4, v65
    v_mov_b32 v66, 0x3f80
    v_lshlrev_b32 v66, v65, v66
    v_lshrrev_b32 v65, 1, v64
    v_bfe_u32 v67, v0, 3, 1
    v_lshrrev_b32 v68, 5, v0
    v_cmp_eq_u32 vcc, v67, v68
    s_nop 1
    v_cndmask_b32 v66, 0, v66, vcc

    v_cmp_eq_u32 vcc, 0, v65
    s_nop 1
    v_cndmask_b32 v8, 0, v66, vcc

    v_cmp_eq_u32 vcc, 1, v65
    s_nop 1
    v_cndmask_b32 v9, 0, v66, vcc

    v_cmp_eq_u32 vcc, 2, v65
    s_nop 1
    v_cndmask_b32 v10, 0, v66, vcc

    v_cmp_eq_u32 vcc, 3, v65
    s_nop 1
    v_cndmask_b32 v11, 0, v66, vcc

    s_lshr_b32 s62, s2, 3
    s_mul_i32 s62, s62, 49
    v_add_u32 v30, s62, v0
    v_lshlrev_b32 v30, 7, v30
    v_mov_b32 v73, 2147483632
    v_cmp_gt_u32 vcc, 49, v0
    s_nop 1
    v_cndmask_b32 v30, v73, v30, vcc

    s_lshr_b32 s62, s2, 3
    s_lshl_b32 s62, s62, 8
    s_and_b32 s63, s2, 7
    s_lshl_b32 s63, s63, 2
    s_add_u32 s71, s62, s63
    s_add_u32 s71, s71, 13631488

    s_mov_b32 s67, 1
    v_mov_b32 v5, 2147483632
    v_mov_b32 v6, 0
    v_mov_b32 v29, 0
    v_mov_b32 v4, 0
    s_mov_b64 s[68:69], 0
    s_cmp_ge_u32 s3, 13
    s_cbranch_scc1 p_kernel_spinit
    s_setprio 3
    v_lshrrev_b32 v64, 5, v0
    v_bfe_u32 v65, v0, 3, 1
    v_lshl_add_u32 v69, v64, 1, v65
    v_lshlrev_b32 v64, 3, v69
    s_lshl_b32 s63, s3, 5
    s_add_u32 s63, s63, 137344
    v_add_u32 v64, s63, v64
    ds_read_b64 v[66:67], v64
    v_lshrrev_b32 v4, 3, v0
    v_lshlrev_b32 v4, 4, v4
    s_lshl_b32 s62, s3, 10
    s_add_u32 s62, s62, 102400
    v_add_u32 v4, s62, v4
    s_lshl_b32 s62, s3, 2
    s_sub_u32 s63, 100, s62
    v_mov_b32 v70, s62
    v_mov_b32 v71, s63
    v_bfe_u32 v68, v0, 4, 1
    v_cmp_eq_u32 vcc, 1, v68
    s_nop 1
    v_cndmask_b32 v70, v70, v71, vcc
    v_add_u32 v70, v70, v69
    v_lshlrev_b32 v6, 10, v70
    v_lshlrev_b32 v29, 5, v70
    v_add_u32 v29, 134144, v29
    s_waitcnt lgkmcnt(0)
    v_and_b32 v7, 0xffff0000, v66
    v_and_b32 v28, 0xffff0000, v67
    v_cndmask_b32 v68, v66, v67, vcc
    v_and_b32 v68, 0xffff, v68
    v_lshl_add_u32 v5, v68, 7, v1
    v_cmp_ne_u32 vcc, 0xffff, v68
    s_mov_b64 s[68:69], vcc
    s_branch p_kernel_hop

p_kernel_spinit:
    s_cmp_lg_u32 s3, 13
    s_cbranch_scc1 p_kernel_hop
    v_mov_b32 v65, s71
    v_mov_b32 v66, 6
    v_cmp_eq_u32 vcc, 0, v0
    s_and_saveexec_b64 s[60:61], vcc
    buffer_store_dword v66, v65, s[12:15], 0 offen sc1
    s_mov_b64 exec, s[60:61]

p_kernel_hop:
    s_cmp_lt_u32 s3, 13
    s_cbranch_scc1 p_kernel_hw
    s_cmp_eq_u32 s3, 14
    s_cbranch_scc1 p_kernel_chk
    s_cmp_eq_u32 s3, 15
    s_cbranch_scc1 p_kernel_w15

    s_branch p_kernel_hw
p_kernel_chk:
    s_cmp_lg_u32 s67, 2
    s_cbranch_scc1 p_kernel_ck2
    s_mov_b32 s63, 2
    s_branch p_kernel_ckgo

p_kernel_ck2:
    s_cmp_lg_u32 s67, 3
    s_cbranch_scc1 p_kernel_ck3
    s_mov_b32 s63, 3
    s_branch p_kernel_ckgo

p_kernel_ck3:
    s_cmp_lg_u32 s67, 4
    s_cbranch_scc1 p_kernel_ck4
    s_mov_b32 s63, 4
    s_branch p_kernel_ckgo

p_kernel_ck4:
    s_cmp_lg_u32 s67, 5
    s_cbranch_scc1 p_kernel_ck5
    s_mov_b32 s63, 5
    s_branch p_kernel_ckgo

p_kernel_ck5:
    s_cmp_lg_u32 s67, 6
    s_cbranch_scc1 p_kernel_ck6
    s_mov_b32 s63, 6
    s_branch p_kernel_ckgo

p_kernel_ck6:
    s_branch p_kernel_hw
p_kernel_ckgo:
    v_lshrrev_b32 v65, 1, v0
    v_lshlrev_b32 v65, 8, v65
    v_and_b32 v66, 1, v0
    v_lshl_add_u32 v65, v66, 4, v65
    s_mov_b32 s62, 13631488

p_kernel_pollc:
    buffer_load_dwordx4 v[68:71], v65, s[12:15], s62 offen sc1
    s_waitcnt vmcnt(0)
    v_min_u32 v68, v68, v69
    v_min3_u32 v68, v68, v70, v71
    v_cmp_gt_u32 vcc, s63, v68
    s_cbranch_vccz p_kernel_hw
    s_sleep 32
    s_sub_u32 s66, s66, 1
    s_cbranch_scc0 p_kernel_pollc
    s_mov_b32 s66, 0
    s_branch p_kernel_hw

p_kernel_w15:
    s_cmp_lg_u32 s67, 3
    s_cbranch_scc1 p_kernel_hw
    s_cmp_lg_u32 s3, 15
    s_cbranch_scc1 p_kernel_hw
    v_mov_b32 v65, 13639680

p_kernel_poll:
    buffer_load_dword v66, v65, s[12:15], 0 offen sc1
    s_waitcnt vmcnt(0)
    v_readfirstlane_b32 s62, v66
    s_cmp_lg_u32 s62, 0
    s_cbranch_scc1 p_kernel_spw
    s_sleep 32
    s_sub_u32 s66, s66, 1
    s_cbranch_scc0 p_kernel_poll
    s_mov_b32 s66, 0

p_kernel_spw:
    v_lshlrev_b32 v64, 4, v0
    s_mov_b32 s63, 12582912
    s_mov_b32 s62, 115712

    s_mov_b32 m0, s62
    s_add_u32 s62, s62, 1024
    buffer_load_dwordx4 v64, s[12:15], s63 offen sc1 lds
    s_add_u32 s63, s63, 1024

    s_mov_b32 m0, s62
    s_add_u32 s62, s62, 1024
    buffer_load_dwordx4 v64, s[12:15], s63 offen sc1 lds
    s_add_u32 s63, s63, 1024

    s_mov_b32 m0, s62
    s_add_u32 s62, s62, 1024
    buffer_load_dwordx4 v64, s[12:15], s63 offen sc1 lds
    s_add_u32 s63, s63, 1024

    s_mov_b32 m0, s62
    s_add_u32 s62, s62, 1024
    buffer_load_dwordx4 v64, s[12:15], s63 offen sc1 lds
    s_add_u32 s63, s63, 1024

    s_mov_b32 m0, s62
    s_add_u32 s62, s62, 1024
    buffer_load_dwordx4 v64, s[12:15], s63 offen sc1 lds
    s_add_u32 s63, s63, 1024

    s_mov_b32 m0, s62
    s_add_u32 s62, s62, 1024
    buffer_load_dwordx4 v64, s[12:15], s63 offen sc1 lds
    s_add_u32 s63, s63, 1024

    s_mov_b32 m0, s62
    s_add_u32 s62, s62, 1024
    buffer_load_dwordx4 v64, s[12:15], s63 offen sc1 lds
    s_add_u32 s63, s63, 1024

    s_mov_b32 m0, s62
    s_add_u32 s62, s62, 1024
    buffer_load_dwordx4 v64, s[12:15], s63 offen sc1 lds
    s_add_u32 s63, s63, 1024

    s_mov_b32 m0, s62
    s_add_u32 s62, s62, 1024
    buffer_load_dwordx4 v64, s[12:15], s63 offen sc1 lds
    s_add_u32 s63, s63, 1024

    s_mov_b32 m0, s62
    s_add_u32 s62, s62, 1024
    buffer_load_dwordx4 v64, s[12:15], s63 offen sc1 lds
    s_add_u32 s63, s63, 1024

    s_mov_b32 m0, s62
    s_add_u32 s62, s62, 1024
    buffer_load_dwordx4 v64, s[12:15], s63 offen sc1 lds
    s_add_u32 s63, s63, 1024

    s_mov_b32 m0, s62
    s_add_u32 s62, s62, 1024
    buffer_load_dwordx4 v64, s[12:15], s63 offen sc1 lds
    s_add_u32 s63, s63, 1024

    s_mov_b32 m0, s62
    s_add_u32 s62, s62, 1024
    buffer_load_dwordx4 v64, s[12:15], s63 offen sc1 lds
    s_add_u32 s63, s63, 1024

    s_mov_b32 m0, s62
    s_add_u32 s62, s62, 1024
    buffer_load_dwordx4 v64, s[12:15], s63 offen sc1 lds
    s_add_u32 s63, s63, 1024

    s_mov_b32 m0, s62
    s_add_u32 s62, s62, 1024
    buffer_load_dwordx4 v64, s[12:15], s63 offen sc1 lds
    s_add_u32 s63, s63, 1024

    s_mov_b32 m0, s62
    s_add_u32 s62, s62, 1024
    buffer_load_dwordx4 v64, s[12:15], s63 offen sc1 lds
    s_add_u32 s63, s63, 1024

    s_mov_b32 m0, s62
    s_add_u32 s62, s62, 1024
    buffer_load_dwordx4 v64, s[12:15], s63 offen sc1 lds
    s_add_u32 s63, s63, 1024

    s_mov_b32 m0, s62
    s_add_u32 s62, s62, 1024
    buffer_load_dwordx4 v64, s[12:15], s63 offen sc1 lds
    s_add_u32 s63, s63, 1024

    s_waitcnt vmcnt(0)
p_kernel_hw:
    s_cmp_lg_u32 s50, 0
    s_cbranch_scc1 p_kernel_slow
    s_cmp_ge_u32 s3, 13
    s_cbranch_scc1 p_kernel_hopend
    s_mov_b32 s52, s58
    s_mov_b64 s[54:55], s[56:57]
    v_mov_b32 v3, v4

    ds_read_b128 v[20:23], v3
    ds_read_b128 v[24:27], v3 offset:128

    v_mov_b32 v12, 0
    v_mov_b32 v16, 0
    v_mov_b32 v13, 0
    v_mov_b32 v17, 0
    v_mov_b32 v14, 0
    v_mov_b32 v18, 0
    v_mov_b32 v15, 0
    v_mov_b32 v19, 0
    s_cmp_eq_u32 s67, 1
    s_cbranch_scc1 p_kernel_nohs
    s_sleep 12

p_kernel_nohs:
    s_waitcnt lgkmcnt(0)
    v_mad_u32_u16 v116, v20, v2, v1 op_sel:[0,0,0,0]
    buffer_load_dwordx4 v[32:35], v116, s[32:35], 0 offen sc1
    v_mad_u32_u16 v117, v20, v2, v1 op_sel:[1,0,0,0]
    buffer_load_dwordx4 v[36:39], v117, s[32:35], 0 offen sc1
    v_mad_u32_u16 v118, v21, v2, v1 op_sel:[0,0,0,0]
    buffer_load_dwordx4 v[40:43], v118, s[32:35], 0 offen sc1
    v_mad_u32_u16 v119, v21, v2, v1 op_sel:[1,0,0,0]
    buffer_load_dwordx4 v[44:47], v119, s[32:35], 0 offen sc1
    s_cmp_eq_u32 s67, 1
    s_cbranch_scc1 p_kernel_nost
    s_lshl_b32 s62, s67, 2
    s_sub_u32 s62, s62, 4

    v_dot2_f32_bf16 v65, v84, s70, 0
    v_dot2_f32_bf16 v66, v84, v84, 0
    v_dot2_f32_bf16 v65, v85, s70, v65
    v_dot2_f32_bf16 v66, v85, v85, v66
    v_dot2_f32_bf16 v65, v86, s70, v65
    v_dot2_f32_bf16 v66, v86, v86, v66
    v_dot2_f32_bf16 v65, v87, s70, v65
    v_dot2_f32_bf16 v66, v87, v87, v66
    s_nop 1
    v_add_f32_dpp v65, v65, v65 quad_perm:[1,0,3,2] row_mask:0xf bank_mask:0xf
    v_add_f32_dpp v66, v66, v66 quad_perm:[1,0,3,2] row_mask:0xf bank_mask:0xf
    s_nop 0
    v_add_f32_dpp v65, v65, v65 quad_perm:[2,3,0,1] row_mask:0xf bank_mask:0xf
    v_add_f32_dpp v66, v66, v66 quad_perm:[2,3,0,1] row_mask:0xf bank_mask:0xf
    s_nop 0
    v_add_f32_dpp v65, v65, v65 row_half_mirror row_mask:0xf bank_mask:0xf
    v_add_f32_dpp v66, v66, v66 row_half_mirror row_mask:0xf bank_mask:0xf
    v_mul_f32 v65, 0x3c800000, v65
    v_mul_f32 v66, 0x3c800000, v66
    v_fma_f32 v67, -v65, v65, v66
    v_max_f32 v67, 0, v67
    v_add_f32 v67, 0x3727c5ac, v67
    v_rsq_f32 v64, v67

    v_add_u32 v68, s62, v29
    s_mov_b64 exec, s[68:69]
    ds_write_b32 v68, v64
    s_mov_b64 exec, -1

p_kernel_nost:
p_kernel_loop:
    s_waitcnt vmcnt(3)
    v_cmp_eq_u32 vcc, -1, v32
    s_cbranch_vccnz p_kernel_rtm0
p_kernel_rbm0:
    s_bitcmp1_b32 s54, 0
    s_cbranch_scc1 p_kernel_qm0
    v_mfma_f32_16x16x32_bf16 v[16:19], v[8:11], v[32:35], v[16:19]
p_kernel_qbm0:
    s_sub_u32 s52, s52, 1
    s_cbranch_scc1 p_kernel_dr0
    v_mad_u32_u16 v116, v22, v2, v1 op_sel:[0,0,0,0]
    buffer_load_dwordx4 v[32:35], v116, s[32:35], 0 offen sc1
    s_waitcnt vmcnt(3)
    v_cmp_eq_u32 vcc, -1, v36
    s_cbranch_vccnz p_kernel_rtm1
p_kernel_rbm1:
    s_bitcmp1_b32 s54, 1
    s_cbranch_scc1 p_kernel_qm1
    v_mfma_f32_16x16x32_bf16 v[16:19], v[8:11], v[36:39], v[16:19]
p_kernel_qbm1:
    s_sub_u32 s52, s52, 1
    s_cbranch_scc1 p_kernel_dr1
    v_mad_u32_u16 v117, v22, v2, v1 op_sel:[1,0,0,0]
    buffer_load_dwordx4 v[36:39], v117, s[32:35], 0 offen sc1
    s_waitcnt vmcnt(3)
    v_cmp_eq_u32 vcc, -1, v40
    s_cbranch_vccnz p_kernel_rtm2
p_kernel_rbm2:
    s_bitcmp1_b32 s54, 2
    s_cbranch_scc1 p_kernel_qm2
    v_mfma_f32_16x16x32_bf16 v[16:19], v[8:11], v[40:43], v[16:19]
p_kernel_qbm2:
    s_sub_u32 s52, s52, 1
    s_cbranch_scc1 p_kernel_dr2
    v_mad_u32_u16 v118, v23, v2, v1 op_sel:[0,0,0,0]
    buffer_load_dwordx4 v[40:43], v118, s[32:35], 0 offen sc1
    s_waitcnt vmcnt(3)
    v_cmp_eq_u32 vcc, -1, v44
    s_cbranch_vccnz p_kernel_rtm3
p_kernel_rbm3:
    s_bitcmp1_b32 s54, 3
    s_cbranch_scc1 p_kernel_qm3
    v_mfma_f32_16x16x32_bf16 v[16:19], v[8:11], v[44:47], v[16:19]
p_kernel_qbm3:
    s_sub_u32 s52, s52, 1
    s_cbranch_scc1 p_kernel_dr3
    v_mad_u32_u16 v119, v23, v2, v1 op_sel:[1,0,0,0]
    buffer_load_dwordx4 v[44:47], v119, s[32:35], 0 offen sc1
    s_waitcnt vmcnt(3)
    v_cmp_eq_u32 vcc, -1, v32
    s_cbranch_vccnz p_kernel_rtm4
p_kernel_rbm4:
    s_bitcmp1_b32 s54, 4
    s_cbranch_scc1 p_kernel_qm4
    v_mfma_f32_16x16x32_bf16 v[16:19], v[8:11], v[32:35], v[16:19]
p_kernel_qbm4:
    s_sub_u32 s52, s52, 1
    s_cbranch_scc1 p_kernel_dr4
    s_waitcnt lgkmcnt(0)
    v_mad_u32_u16 v116, v24, v2, v1 op_sel:[0,0,0,0]
    buffer_load_dwordx4 v[32:35], v116, s[32:35], 0 offen sc1
    s_waitcnt vmcnt(3)
    v_cmp_eq_u32 vcc, -1, v36
    s_cbranch_vccnz p_kernel_rtm5
p_kernel_rbm5:
    s_bitcmp1_b32 s54, 5
    s_cbranch_scc1 p_kernel_qm5
    v_mfma_f32_16x16x32_bf16 v[16:19], v[8:11], v[36:39], v[16:19]
p_kernel_qbm5:
    s_sub_u32 s52, s52, 1
    s_cbranch_scc1 p_kernel_dr5
    v_mad_u32_u16 v117, v24, v2, v1 op_sel:[1,0,0,0]
    buffer_load_dwordx4 v[36:39], v117, s[32:35], 0 offen sc1
    s_waitcnt vmcnt(3)
    v_cmp_eq_u32 vcc, -1, v40
    s_cbranch_vccnz p_kernel_rtm6
p_kernel_rbm6:
    s_bitcmp1_b32 s54, 6
    s_cbranch_scc1 p_kernel_qm6
    v_mfma_f32_16x16x32_bf16 v[16:19], v[8:11], v[40:43], v[16:19]
p_kernel_qbm6:
    s_sub_u32 s52, s52, 1
    s_cbranch_scc1 p_kernel_dr6
    v_mad_u32_u16 v118, v25, v2, v1 op_sel:[0,0,0,0]
    buffer_load_dwordx4 v[40:43], v118, s[32:35], 0 offen sc1
    s_waitcnt vmcnt(3)
    v_cmp_eq_u32 vcc, -1, v44
    s_cbranch_vccnz p_kernel_rtm7
p_kernel_rbm7:
    s_bitcmp1_b32 s54, 7
    s_cbranch_scc1 p_kernel_qm7
    v_mfma_f32_16x16x32_bf16 v[16:19], v[8:11], v[44:47], v[16:19]
p_kernel_qbm7:
    s_sub_u32 s52, s52, 1
    s_cbranch_scc1 p_kernel_dr7
    v_mad_u32_u16 v119, v25, v2, v1 op_sel:[1,0,0,0]
    buffer_load_dwordx4 v[44:47], v119, s[32:35], 0 offen sc1
    v_mov_b32 v20, v24
    v_mov_b32 v21, v25
    v_mov_b32 v22, v26
    v_mov_b32 v23, v27
    ds_read_b128 v[24:27], v3 offset:256
    v_add_u32 v3, 128, v3
    s_lshr_b64 s[54:55], s[54:55], 8
    s_branch p_kernel_loop

p_kernel_dr0:
    s_waitcnt vmcnt(2)
    v_cmp_eq_u32 vcc, -1, v36
    s_cbranch_vccnz p_kernel_rtd0_0
p_kernel_rbd0_0:
    s_bitcmp1_b32 s54, 1
    s_cbranch_scc1 p_kernel_qd0_0
    v_mfma_f32_16x16x32_bf16 v[16:19], v[8:11], v[36:39], v[16:19]
p_kernel_qbd0_0:
    s_waitcnt vmcnt(1)
    v_cmp_eq_u32 vcc, -1, v40
    s_cbranch_vccnz p_kernel_rtd0_1
p_kernel_rbd0_1:
    s_bitcmp1_b32 s54, 2
    s_cbranch_scc1 p_kernel_qd0_1
    v_mfma_f32_16x16x32_bf16 v[16:19], v[8:11], v[40:43], v[16:19]
p_kernel_qbd0_1:
    s_waitcnt vmcnt(0)
    v_cmp_eq_u32 vcc, -1, v44
    s_cbranch_vccnz p_kernel_rtd0_2
p_kernel_rbd0_2:
    s_bitcmp1_b32 s54, 3
    s_cbranch_scc1 p_kernel_qd0_2
    v_mfma_f32_16x16x32_bf16 v[16:19], v[8:11], v[44:47], v[16:19]
p_kernel_qbd0_2:
    s_branch p_kernel_done
p_kernel_dr1:
    s_waitcnt vmcnt(2)
    v_cmp_eq_u32 vcc, -1, v40
    s_cbranch_vccnz p_kernel_rtd1_0
p_kernel_rbd1_0:
    s_bitcmp1_b32 s54, 2
    s_cbranch_scc1 p_kernel_qd1_0
    v_mfma_f32_16x16x32_bf16 v[16:19], v[8:11], v[40:43], v[16:19]
p_kernel_qbd1_0:
    s_waitcnt vmcnt(1)
    v_cmp_eq_u32 vcc, -1, v44
    s_cbranch_vccnz p_kernel_rtd1_1
p_kernel_rbd1_1:
    s_bitcmp1_b32 s54, 3
    s_cbranch_scc1 p_kernel_qd1_1
    v_mfma_f32_16x16x32_bf16 v[16:19], v[8:11], v[44:47], v[16:19]
p_kernel_qbd1_1:
    s_waitcnt vmcnt(0)
    v_cmp_eq_u32 vcc, -1, v32
    s_cbranch_vccnz p_kernel_rtd1_2
p_kernel_rbd1_2:
    s_bitcmp1_b32 s54, 4
    s_cbranch_scc1 p_kernel_qd1_2
    v_mfma_f32_16x16x32_bf16 v[16:19], v[8:11], v[32:35], v[16:19]
p_kernel_qbd1_2:
    s_branch p_kernel_done
p_kernel_dr2:
    s_waitcnt vmcnt(2)
    v_cmp_eq_u32 vcc, -1, v44
    s_cbranch_vccnz p_kernel_rtd2_0
p_kernel_rbd2_0:
    s_bitcmp1_b32 s54, 3
    s_cbranch_scc1 p_kernel_qd2_0
    v_mfma_f32_16x16x32_bf16 v[16:19], v[8:11], v[44:47], v[16:19]
p_kernel_qbd2_0:
    s_waitcnt vmcnt(1)
    v_cmp_eq_u32 vcc, -1, v32
    s_cbranch_vccnz p_kernel_rtd2_1
p_kernel_rbd2_1:
    s_bitcmp1_b32 s54, 4
    s_cbranch_scc1 p_kernel_qd2_1
    v_mfma_f32_16x16x32_bf16 v[16:19], v[8:11], v[32:35], v[16:19]
p_kernel_qbd2_1:
    s_waitcnt vmcnt(0)
    v_cmp_eq_u32 vcc, -1, v36
    s_cbranch_vccnz p_kernel_rtd2_2
p_kernel_rbd2_2:
    s_bitcmp1_b32 s54, 5
    s_cbranch_scc1 p_kernel_qd2_2
    v_mfma_f32_16x16x32_bf16 v[16:19], v[8:11], v[36:39], v[16:19]
p_kernel_qbd2_2:
    s_branch p_kernel_done
p_kernel_dr3:
    s_waitcnt vmcnt(2)
    v_cmp_eq_u32 vcc, -1, v32
    s_cbranch_vccnz p_kernel_rtd3_0
p_kernel_rbd3_0:
    s_bitcmp1_b32 s54, 4
    s_cbranch_scc1 p_kernel_qd3_0
    v_mfma_f32_16x16x32_bf16 v[16:19], v[8:11], v[32:35], v[16:19]
p_kernel_qbd3_0:
    s_waitcnt vmcnt(1)
    v_cmp_eq_u32 vcc, -1, v36
    s_cbranch_vccnz p_kernel_rtd3_1
p_kernel_rbd3_1:
    s_bitcmp1_b32 s54, 5
    s_cbranch_scc1 p_kernel_qd3_1
    v_mfma_f32_16x16x32_bf16 v[16:19], v[8:11], v[36:39], v[16:19]
p_kernel_qbd3_1:
    s_waitcnt vmcnt(0)
    v_cmp_eq_u32 vcc, -1, v40
    s_cbranch_vccnz p_kernel_rtd3_2
p_kernel_rbd3_2:
    s_bitcmp1_b32 s54, 6
    s_cbranch_scc1 p_kernel_qd3_2
    v_mfma_f32_16x16x32_bf16 v[16:19], v[8:11], v[40:43], v[16:19]
p_kernel_qbd3_2:
    s_branch p_kernel_done
p_kernel_dr4:
    s_waitcnt vmcnt(2)
    v_cmp_eq_u32 vcc, -1, v36
    s_cbranch_vccnz p_kernel_rtd4_0
p_kernel_rbd4_0:
    s_bitcmp1_b32 s54, 5
    s_cbranch_scc1 p_kernel_qd4_0
    v_mfma_f32_16x16x32_bf16 v[16:19], v[8:11], v[36:39], v[16:19]
p_kernel_qbd4_0:
    s_waitcnt vmcnt(1)
    v_cmp_eq_u32 vcc, -1, v40
    s_cbranch_vccnz p_kernel_rtd4_1
p_kernel_rbd4_1:
    s_bitcmp1_b32 s54, 6
    s_cbranch_scc1 p_kernel_qd4_1
    v_mfma_f32_16x16x32_bf16 v[16:19], v[8:11], v[40:43], v[16:19]
p_kernel_qbd4_1:
    s_waitcnt vmcnt(0)
    v_cmp_eq_u32 vcc, -1, v44
    s_cbranch_vccnz p_kernel_rtd4_2
p_kernel_rbd4_2:
    s_bitcmp1_b32 s54, 7
    s_cbranch_scc1 p_kernel_qd4_2
    v_mfma_f32_16x16x32_bf16 v[16:19], v[8:11], v[44:47], v[16:19]
p_kernel_qbd4_2:
    s_branch p_kernel_done
p_kernel_dr5:
    s_waitcnt vmcnt(2)
    v_cmp_eq_u32 vcc, -1, v40
    s_cbranch_vccnz p_kernel_rtd5_0
p_kernel_rbd5_0:
    s_bitcmp1_b32 s54, 6
    s_cbranch_scc1 p_kernel_qd5_0
    v_mfma_f32_16x16x32_bf16 v[16:19], v[8:11], v[40:43], v[16:19]
p_kernel_qbd5_0:
    s_waitcnt vmcnt(1)
    v_cmp_eq_u32 vcc, -1, v44
    s_cbranch_vccnz p_kernel_rtd5_1
p_kernel_rbd5_1:
    s_bitcmp1_b32 s54, 7
    s_cbranch_scc1 p_kernel_qd5_1
    v_mfma_f32_16x16x32_bf16 v[16:19], v[8:11], v[44:47], v[16:19]
p_kernel_qbd5_1:
    s_waitcnt vmcnt(0)
    v_cmp_eq_u32 vcc, -1, v32
    s_cbranch_vccnz p_kernel_rtd5_2
p_kernel_rbd5_2:
    s_bitcmp1_b32 s54, 8
    s_cbranch_scc1 p_kernel_qd5_2
    v_mfma_f32_16x16x32_bf16 v[16:19], v[8:11], v[32:35], v[16:19]
p_kernel_qbd5_2:
    s_branch p_kernel_done
p_kernel_dr6:
    s_waitcnt vmcnt(2)
    v_cmp_eq_u32 vcc, -1, v44
    s_cbranch_vccnz p_kernel_rtd6_0
p_kernel_rbd6_0:
    s_bitcmp1_b32 s54, 7
    s_cbranch_scc1 p_kernel_qd6_0
    v_mfma_f32_16x16x32_bf16 v[16:19], v[8:11], v[44:47], v[16:19]
p_kernel_qbd6_0:
    s_waitcnt vmcnt(1)
    v_cmp_eq_u32 vcc, -1, v32
    s_cbranch_vccnz p_kernel_rtd6_1
p_kernel_rbd6_1:
    s_bitcmp1_b32 s54, 8
    s_cbranch_scc1 p_kernel_qd6_1
    v_mfma_f32_16x16x32_bf16 v[16:19], v[8:11], v[32:35], v[16:19]
p_kernel_qbd6_1:
    s_waitcnt vmcnt(0)
    v_cmp_eq_u32 vcc, -1, v36
    s_cbranch_vccnz p_kernel_rtd6_2
p_kernel_rbd6_2:
    s_bitcmp1_b32 s54, 9
    s_cbranch_scc1 p_kernel_qd6_2
    v_mfma_f32_16x16x32_bf16 v[16:19], v[8:11], v[36:39], v[16:19]
p_kernel_qbd6_2:
    s_branch p_kernel_done
p_kernel_dr7:
    s_waitcnt vmcnt(2)
    v_cmp_eq_u32 vcc, -1, v32
    s_cbranch_vccnz p_kernel_rtd7_0
p_kernel_rbd7_0:
    s_bitcmp1_b32 s54, 8
    s_cbranch_scc1 p_kernel_qd7_0
    v_mfma_f32_16x16x32_bf16 v[16:19], v[8:11], v[32:35], v[16:19]
p_kernel_qbd7_0:
    s_waitcnt vmcnt(1)
    v_cmp_eq_u32 vcc, -1, v36
    s_cbranch_vccnz p_kernel_rtd7_1
p_kernel_rbd7_1:
    s_bitcmp1_b32 s54, 9
    s_cbranch_scc1 p_kernel_qd7_1
    v_mfma_f32_16x16x32_bf16 v[16:19], v[8:11], v[36:39], v[16:19]
p_kernel_qbd7_1:
    s_waitcnt vmcnt(0)
    v_cmp_eq_u32 vcc, -1, v40
    s_cbranch_vccnz p_kernel_rtd7_2
p_kernel_rbd7_2:
    s_bitcmp1_b32 s54, 10
    s_cbranch_scc1 p_kernel_qd7_2
    v_mfma_f32_16x16x32_bf16 v[16:19], v[8:11], v[40:43], v[16:19]
p_kernel_qbd7_2:
    s_branch p_kernel_done
p_kernel_qm0:
    v_mfma_f32_16x16x32_bf16 v[12:15], v[8:11], v[32:35], v[12:15]
    s_branch p_kernel_qbm0
p_kernel_qm1:
    v_mfma_f32_16x16x32_bf16 v[12:15], v[8:11], v[36:39], v[12:15]
    s_branch p_kernel_qbm1
p_kernel_qm2:
    v_mfma_f32_16x16x32_bf16 v[12:15], v[8:11], v[40:43], v[12:15]
    s_branch p_kernel_qbm2
p_kernel_qm3:
    v_mfma_f32_16x16x32_bf16 v[12:15], v[8:11], v[44:47], v[12:15]
    s_branch p_kernel_qbm3
p_kernel_qm4:
    v_mfma_f32_16x16x32_bf16 v[12:15], v[8:11], v[32:35], v[12:15]
    s_branch p_kernel_qbm4
p_kernel_qm5:
    v_mfma_f32_16x16x32_bf16 v[12:15], v[8:11], v[36:39], v[12:15]
    s_branch p_kernel_qbm5
p_kernel_qm6:
    v_mfma_f32_16x16x32_bf16 v[12:15], v[8:11], v[40:43], v[12:15]
    s_branch p_kernel_qbm6
p_kernel_qm7:
    v_mfma_f32_16x16x32_bf16 v[12:15], v[8:11], v[44:47], v[12:15]
    s_branch p_kernel_qbm7
p_kernel_qd0_0:
    v_mfma_f32_16x16x32_bf16 v[12:15], v[8:11], v[36:39], v[12:15]
    s_branch p_kernel_qbd0_0
p_kernel_qd0_1:
    v_mfma_f32_16x16x32_bf16 v[12:15], v[8:11], v[40:43], v[12:15]
    s_branch p_kernel_qbd0_1
p_kernel_qd0_2:
    v_mfma_f32_16x16x32_bf16 v[12:15], v[8:11], v[44:47], v[12:15]
    s_branch p_kernel_qbd0_2
p_kernel_qd1_0:
    v_mfma_f32_16x16x32_bf16 v[12:15], v[8:11], v[40:43], v[12:15]
    s_branch p_kernel_qbd1_0
p_kernel_qd1_1:
    v_mfma_f32_16x16x32_bf16 v[12:15], v[8:11], v[44:47], v[12:15]
    s_branch p_kernel_qbd1_1
p_kernel_qd1_2:
    v_mfma_f32_16x16x32_bf16 v[12:15], v[8:11], v[32:35], v[12:15]
    s_branch p_kernel_qbd1_2
p_kernel_qd2_0:
    v_mfma_f32_16x16x32_bf16 v[12:15], v[8:11], v[44:47], v[12:15]
    s_branch p_kernel_qbd2_0
p_kernel_qd2_1:
    v_mfma_f32_16x16x32_bf16 v[12:15], v[8:11], v[32:35], v[12:15]
    s_branch p_kernel_qbd2_1
p_kernel_qd2_2:
    v_mfma_f32_16x16x32_bf16 v[12:15], v[8:11], v[36:39], v[12:15]
    s_branch p_kernel_qbd2_2
p_kernel_qd3_0:
    v_mfma_f32_16x16x32_bf16 v[12:15], v[8:11], v[32:35], v[12:15]
    s_branch p_kernel_qbd3_0
p_kernel_qd3_1:
    v_mfma_f32_16x16x32_bf16 v[12:15], v[8:11], v[36:39], v[12:15]
    s_branch p_kernel_qbd3_1
p_kernel_qd3_2:
    v_mfma_f32_16x16x32_bf16 v[12:15], v[8:11], v[40:43], v[12:15]
    s_branch p_kernel_qbd3_2
p_kernel_qd4_0:
    v_mfma_f32_16x16x32_bf16 v[12:15], v[8:11], v[36:39], v[12:15]
    s_branch p_kernel_qbd4_0
p_kernel_qd4_1:
    v_mfma_f32_16x16x32_bf16 v[12:15], v[8:11], v[40:43], v[12:15]
    s_branch p_kernel_qbd4_1
p_kernel_qd4_2:
    v_mfma_f32_16x16x32_bf16 v[12:15], v[8:11], v[44:47], v[12:15]
    s_branch p_kernel_qbd4_2
p_kernel_qd5_0:
    v_mfma_f32_16x16x32_bf16 v[12:15], v[8:11], v[40:43], v[12:15]
    s_branch p_kernel_qbd5_0
p_kernel_qd5_1:
    v_mfma_f32_16x16x32_bf16 v[12:15], v[8:11], v[44:47], v[12:15]
    s_branch p_kernel_qbd5_1
p_kernel_qd5_2:
    v_mfma_f32_16x16x32_bf16 v[12:15], v[8:11], v[32:35], v[12:15]
    s_branch p_kernel_qbd5_2
p_kernel_qd6_0:
    v_mfma_f32_16x16x32_bf16 v[12:15], v[8:11], v[44:47], v[12:15]
    s_branch p_kernel_qbd6_0
p_kernel_qd6_1:
    v_mfma_f32_16x16x32_bf16 v[12:15], v[8:11], v[32:35], v[12:15]
    s_branch p_kernel_qbd6_1
p_kernel_qd6_2:
    v_mfma_f32_16x16x32_bf16 v[12:15], v[8:11], v[36:39], v[12:15]
    s_branch p_kernel_qbd6_2
p_kernel_qd7_0:
    v_mfma_f32_16x16x32_bf16 v[12:15], v[8:11], v[32:35], v[12:15]
    s_branch p_kernel_qbd7_0
p_kernel_qd7_1:
    v_mfma_f32_16x16x32_bf16 v[12:15], v[8:11], v[36:39], v[12:15]
    s_branch p_kernel_qbd7_1
p_kernel_qd7_2:
    v_mfma_f32_16x16x32_bf16 v[12:15], v[8:11], v[40:43], v[12:15]
    s_branch p_kernel_qbd7_2
p_kernel_rtm0:
    s_sleep 2
    buffer_load_dwordx4 v[32:35], v116, s[32:35], 0 offen sc1
    s_sub_u32 s66, s66, 1
    s_cbranch_scc1 p_kernel_gum0
    s_waitcnt vmcnt(0)
    v_cmp_eq_u32 vcc, -1, v32
    s_cbranch_vccnz p_kernel_rtm0
    s_branch p_kernel_rbm0

p_kernel_gum0:
    s_mov_b32 s66, 0
    s_waitcnt vmcnt(0)
    s_branch p_kernel_rbm0

p_kernel_rtm1:
    s_sleep 2
    buffer_load_dwordx4 v[36:39], v117, s[32:35], 0 offen sc1
    s_sub_u32 s66, s66, 1
    s_cbranch_scc1 p_kernel_gum1
    s_waitcnt vmcnt(0)
    v_cmp_eq_u32 vcc, -1, v36
    s_cbranch_vccnz p_kernel_rtm1
    s_branch p_kernel_rbm1

p_kernel_gum1:
    s_mov_b32 s66, 0
    s_waitcnt vmcnt(0)
    s_branch p_kernel_rbm1

p_kernel_rtm2:
    s_sleep 2
    buffer_load_dwordx4 v[40:43], v118, s[32:35], 0 offen sc1
    s_sub_u32 s66, s66, 1
    s_cbranch_scc1 p_kernel_gum2
    s_waitcnt vmcnt(0)
    v_cmp_eq_u32 vcc, -1, v40
    s_cbranch_vccnz p_kernel_rtm2
    s_branch p_kernel_rbm2

p_kernel_gum2:
    s_mov_b32 s66, 0
    s_waitcnt vmcnt(0)
    s_branch p_kernel_rbm2

p_kernel_rtm3:
    s_sleep 2
    buffer_load_dwordx4 v[44:47], v119, s[32:35], 0 offen sc1
    s_sub_u32 s66, s66, 1
    s_cbranch_scc1 p_kernel_gum3
    s_waitcnt vmcnt(0)
    v_cmp_eq_u32 vcc, -1, v44
    s_cbranch_vccnz p_kernel_rtm3
    s_branch p_kernel_rbm3

p_kernel_gum3:
    s_mov_b32 s66, 0
    s_waitcnt vmcnt(0)
    s_branch p_kernel_rbm3

p_kernel_rtm4:
    s_sleep 2
    buffer_load_dwordx4 v[32:35], v116, s[32:35], 0 offen sc1
    s_sub_u32 s66, s66, 1
    s_cbranch_scc1 p_kernel_gum4
    s_waitcnt vmcnt(0)
    v_cmp_eq_u32 vcc, -1, v32
    s_cbranch_vccnz p_kernel_rtm4
    s_branch p_kernel_rbm4

p_kernel_gum4:
    s_mov_b32 s66, 0
    s_waitcnt vmcnt(0)
    s_branch p_kernel_rbm4

p_kernel_rtm5:
    s_sleep 2
    buffer_load_dwordx4 v[36:39], v117, s[32:35], 0 offen sc1
    s_sub_u32 s66, s66, 1
    s_cbranch_scc1 p_kernel_gum5
    s_waitcnt vmcnt(0)
    v_cmp_eq_u32 vcc, -1, v36
    s_cbranch_vccnz p_kernel_rtm5
    s_branch p_kernel_rbm5

p_kernel_gum5:
    s_mov_b32 s66, 0
    s_waitcnt vmcnt(0)
    s_branch p_kernel_rbm5

p_kernel_rtm6:
    s_sleep 2
    buffer_load_dwordx4 v[40:43], v118, s[32:35], 0 offen sc1
    s_sub_u32 s66, s66, 1
    s_cbranch_scc1 p_kernel_gum6
    s_waitcnt vmcnt(0)
    v_cmp_eq_u32 vcc, -1, v40
    s_cbranch_vccnz p_kernel_rtm6
    s_branch p_kernel_rbm6

p_kernel_gum6:
    s_mov_b32 s66, 0
    s_waitcnt vmcnt(0)
    s_branch p_kernel_rbm6

p_kernel_rtm7:
    s_sleep 2
    buffer_load_dwordx4 v[44:47], v119, s[32:35], 0 offen sc1
    s_sub_u32 s66, s66, 1
    s_cbranch_scc1 p_kernel_gum7
    s_waitcnt vmcnt(0)
    v_cmp_eq_u32 vcc, -1, v44
    s_cbranch_vccnz p_kernel_rtm7
    s_branch p_kernel_rbm7

p_kernel_gum7:
    s_mov_b32 s66, 0
    s_waitcnt vmcnt(0)
    s_branch p_kernel_rbm7

p_kernel_rtd0_0:
    s_sleep 2
    buffer_load_dwordx4 v[36:39], v117, s[32:35], 0 offen sc1
    s_sub_u32 s66, s66, 1
    s_cbranch_scc1 p_kernel_gud0_0
    s_waitcnt vmcnt(0)
    v_cmp_eq_u32 vcc, -1, v36
    s_cbranch_vccnz p_kernel_rtd0_0
    s_branch p_kernel_rbd0_0

p_kernel_gud0_0:
    s_mov_b32 s66, 0
    s_waitcnt vmcnt(0)
    s_branch p_kernel_rbd0_0

p_kernel_rtd0_1:
    s_sleep 2
    buffer_load_dwordx4 v[40:43], v118, s[32:35], 0 offen sc1
    s_sub_u32 s66, s66, 1
    s_cbranch_scc1 p_kernel_gud0_1
    s_waitcnt vmcnt(0)
    v_cmp_eq_u32 vcc, -1, v40
    s_cbranch_vccnz p_kernel_rtd0_1
    s_branch p_kernel_rbd0_1

p_kernel_gud0_1:
    s_mov_b32 s66, 0
    s_waitcnt vmcnt(0)
    s_branch p_kernel_rbd0_1

p_kernel_rtd0_2:
    s_sleep 2
    buffer_load_dwordx4 v[44:47], v119, s[32:35], 0 offen sc1
    s_sub_u32 s66, s66, 1
    s_cbranch_scc1 p_kernel_gud0_2
    s_waitcnt vmcnt(0)
    v_cmp_eq_u32 vcc, -1, v44
    s_cbranch_vccnz p_kernel_rtd0_2
    s_branch p_kernel_rbd0_2

p_kernel_gud0_2:
    s_mov_b32 s66, 0
    s_waitcnt vmcnt(0)
    s_branch p_kernel_rbd0_2

p_kernel_rtd1_0:
    s_sleep 2
    buffer_load_dwordx4 v[40:43], v118, s[32:35], 0 offen sc1
    s_sub_u32 s66, s66, 1
    s_cbranch_scc1 p_kernel_gud1_0
    s_waitcnt vmcnt(0)
    v_cmp_eq_u32 vcc, -1, v40
    s_cbranch_vccnz p_kernel_rtd1_0
    s_branch p_kernel_rbd1_0

p_kernel_gud1_0:
    s_mov_b32 s66, 0
    s_waitcnt vmcnt(0)
    s_branch p_kernel_rbd1_0

p_kernel_rtd1_1:
    s_sleep 2
    buffer_load_dwordx4 v[44:47], v119, s[32:35], 0 offen sc1
    s_sub_u32 s66, s66, 1
    s_cbranch_scc1 p_kernel_gud1_1
    s_waitcnt vmcnt(0)
    v_cmp_eq_u32 vcc, -1, v44
    s_cbranch_vccnz p_kernel_rtd1_1
    s_branch p_kernel_rbd1_1

p_kernel_gud1_1:
    s_mov_b32 s66, 0
    s_waitcnt vmcnt(0)
    s_branch p_kernel_rbd1_1

p_kernel_rtd1_2:
    s_sleep 2
    buffer_load_dwordx4 v[32:35], v116, s[32:35], 0 offen sc1
    s_sub_u32 s66, s66, 1
    s_cbranch_scc1 p_kernel_gud1_2
    s_waitcnt vmcnt(0)
    v_cmp_eq_u32 vcc, -1, v32
    s_cbranch_vccnz p_kernel_rtd1_2
    s_branch p_kernel_rbd1_2

p_kernel_gud1_2:
    s_mov_b32 s66, 0
    s_waitcnt vmcnt(0)
    s_branch p_kernel_rbd1_2

p_kernel_rtd2_0:
    s_sleep 2
    buffer_load_dwordx4 v[44:47], v119, s[32:35], 0 offen sc1
    s_sub_u32 s66, s66, 1
    s_cbranch_scc1 p_kernel_gud2_0
    s_waitcnt vmcnt(0)
    v_cmp_eq_u32 vcc, -1, v44
    s_cbranch_vccnz p_kernel_rtd2_0
    s_branch p_kernel_rbd2_0

p_kernel_gud2_0:
    s_mov_b32 s66, 0
    s_waitcnt vmcnt(0)
    s_branch p_kernel_rbd2_0

p_kernel_rtd2_1:
    s_sleep 2
    buffer_load_dwordx4 v[32:35], v116, s[32:35], 0 offen sc1
    s_sub_u32 s66, s66, 1
    s_cbranch_scc1 p_kernel_gud2_1
    s_waitcnt vmcnt(0)
    v_cmp_eq_u32 vcc, -1, v32
    s_cbranch_vccnz p_kernel_rtd2_1
    s_branch p_kernel_rbd2_1

p_kernel_gud2_1:
    s_mov_b32 s66, 0
    s_waitcnt vmcnt(0)
    s_branch p_kernel_rbd2_1

p_kernel_rtd2_2:
    s_sleep 2
    buffer_load_dwordx4 v[36:39], v117, s[32:35], 0 offen sc1
    s_sub_u32 s66, s66, 1
    s_cbranch_scc1 p_kernel_gud2_2
    s_waitcnt vmcnt(0)
    v_cmp_eq_u32 vcc, -1, v36
    s_cbranch_vccnz p_kernel_rtd2_2
    s_branch p_kernel_rbd2_2

p_kernel_gud2_2:
    s_mov_b32 s66, 0
    s_waitcnt vmcnt(0)
    s_branch p_kernel_rbd2_2

p_kernel_rtd3_0:
    s_sleep 2
    buffer_load_dwordx4 v[32:35], v116, s[32:35], 0 offen sc1
    s_sub_u32 s66, s66, 1
    s_cbranch_scc1 p_kernel_gud3_0
    s_waitcnt vmcnt(0)
    v_cmp_eq_u32 vcc, -1, v32
    s_cbranch_vccnz p_kernel_rtd3_0
    s_branch p_kernel_rbd3_0

p_kernel_gud3_0:
    s_mov_b32 s66, 0
    s_waitcnt vmcnt(0)
    s_branch p_kernel_rbd3_0

p_kernel_rtd3_1:
    s_sleep 2
    buffer_load_dwordx4 v[36:39], v117, s[32:35], 0 offen sc1
    s_sub_u32 s66, s66, 1
    s_cbranch_scc1 p_kernel_gud3_1
    s_waitcnt vmcnt(0)
    v_cmp_eq_u32 vcc, -1, v36
    s_cbranch_vccnz p_kernel_rtd3_1
    s_branch p_kernel_rbd3_1

p_kernel_gud3_1:
    s_mov_b32 s66, 0
    s_waitcnt vmcnt(0)
    s_branch p_kernel_rbd3_1

p_kernel_rtd3_2:
    s_sleep 2
    buffer_load_dwordx4 v[40:43], v118, s[32:35], 0 offen sc1
    s_sub_u32 s66, s66, 1
    s_cbranch_scc1 p_kernel_gud3_2
    s_waitcnt vmcnt(0)
    v_cmp_eq_u32 vcc, -1, v40
    s_cbranch_vccnz p_kernel_rtd3_2
    s_branch p_kernel_rbd3_2

p_kernel_gud3_2:
    s_mov_b32 s66, 0
    s_waitcnt vmcnt(0)
    s_branch p_kernel_rbd3_2

p_kernel_rtd4_0:
    s_sleep 2
    buffer_load_dwordx4 v[36:39], v117, s[32:35], 0 offen sc1
    s_sub_u32 s66, s66, 1
    s_cbranch_scc1 p_kernel_gud4_0
    s_waitcnt vmcnt(0)
    v_cmp_eq_u32 vcc, -1, v36
    s_cbranch_vccnz p_kernel_rtd4_0
    s_branch p_kernel_rbd4_0

p_kernel_gud4_0:
    s_mov_b32 s66, 0
    s_waitcnt vmcnt(0)
    s_branch p_kernel_rbd4_0

p_kernel_rtd4_1:
    s_sleep 2
    buffer_load_dwordx4 v[40:43], v118, s[32:35], 0 offen sc1
    s_sub_u32 s66, s66, 1
    s_cbranch_scc1 p_kernel_gud4_1
    s_waitcnt vmcnt(0)
    v_cmp_eq_u32 vcc, -1, v40
    s_cbranch_vccnz p_kernel_rtd4_1
    s_branch p_kernel_rbd4_1

p_kernel_gud4_1:
    s_mov_b32 s66, 0
    s_waitcnt vmcnt(0)
    s_branch p_kernel_rbd4_1

p_kernel_rtd4_2:
    s_sleep 2
    buffer_load_dwordx4 v[44:47], v119, s[32:35], 0 offen sc1
    s_sub_u32 s66, s66, 1
    s_cbranch_scc1 p_kernel_gud4_2
    s_waitcnt vmcnt(0)
    v_cmp_eq_u32 vcc, -1, v44
    s_cbranch_vccnz p_kernel_rtd4_2
    s_branch p_kernel_rbd4_2

p_kernel_gud4_2:
    s_mov_b32 s66, 0
    s_waitcnt vmcnt(0)
    s_branch p_kernel_rbd4_2

p_kernel_rtd5_0:
    s_sleep 2
    buffer_load_dwordx4 v[40:43], v118, s[32:35], 0 offen sc1
    s_sub_u32 s66, s66, 1
    s_cbranch_scc1 p_kernel_gud5_0
    s_waitcnt vmcnt(0)
    v_cmp_eq_u32 vcc, -1, v40
    s_cbranch_vccnz p_kernel_rtd5_0
    s_branch p_kernel_rbd5_0

p_kernel_gud5_0:
    s_mov_b32 s66, 0
    s_waitcnt vmcnt(0)
    s_branch p_kernel_rbd5_0

p_kernel_rtd5_1:
    s_sleep 2
    buffer_load_dwordx4 v[44:47], v119, s[32:35], 0 offen sc1
    s_sub_u32 s66, s66, 1
    s_cbranch_scc1 p_kernel_gud5_1
    s_waitcnt vmcnt(0)
    v_cmp_eq_u32 vcc, -1, v44
    s_cbranch_vccnz p_kernel_rtd5_1
    s_branch p_kernel_rbd5_1

p_kernel_gud5_1:
    s_mov_b32 s66, 0
    s_waitcnt vmcnt(0)
    s_branch p_kernel_rbd5_1

p_kernel_rtd5_2:
    s_sleep 2
    buffer_load_dwordx4 v[32:35], v116, s[32:35], 0 offen sc1
    s_sub_u32 s66, s66, 1
    s_cbranch_scc1 p_kernel_gud5_2
    s_waitcnt vmcnt(0)
    v_cmp_eq_u32 vcc, -1, v32
    s_cbranch_vccnz p_kernel_rtd5_2
    s_branch p_kernel_rbd5_2

p_kernel_gud5_2:
    s_mov_b32 s66, 0
    s_waitcnt vmcnt(0)
    s_branch p_kernel_rbd5_2

p_kernel_rtd6_0:
    s_sleep 2
    buffer_load_dwordx4 v[44:47], v119, s[32:35], 0 offen sc1
    s_sub_u32 s66, s66, 1
    s_cbranch_scc1 p_kernel_gud6_0
    s_waitcnt vmcnt(0)
    v_cmp_eq_u32 vcc, -1, v44
    s_cbranch_vccnz p_kernel_rtd6_0
    s_branch p_kernel_rbd6_0

p_kernel_gud6_0:
    s_mov_b32 s66, 0
    s_waitcnt vmcnt(0)
    s_branch p_kernel_rbd6_0

p_kernel_rtd6_1:
    s_sleep 2
    buffer_load_dwordx4 v[32:35], v116, s[32:35], 0 offen sc1
    s_sub_u32 s66, s66, 1
    s_cbranch_scc1 p_kernel_gud6_1
    s_waitcnt vmcnt(0)
    v_cmp_eq_u32 vcc, -1, v32
    s_cbranch_vccnz p_kernel_rtd6_1
    s_branch p_kernel_rbd6_1

p_kernel_gud6_1:
    s_mov_b32 s66, 0
    s_waitcnt vmcnt(0)
    s_branch p_kernel_rbd6_1

p_kernel_rtd6_2:
    s_sleep 2
    buffer_load_dwordx4 v[36:39], v117, s[32:35], 0 offen sc1
    s_sub_u32 s66, s66, 1
    s_cbranch_scc1 p_kernel_gud6_2
    s_waitcnt vmcnt(0)
    v_cmp_eq_u32 vcc, -1, v36
    s_cbranch_vccnz p_kernel_rtd6_2
    s_branch p_kernel_rbd6_2

p_kernel_gud6_2:
    s_mov_b32 s66, 0
    s_waitcnt vmcnt(0)
    s_branch p_kernel_rbd6_2

p_kernel_rtd7_0:
    s_sleep 2
    buffer_load_dwordx4 v[32:35], v116, s[32:35], 0 offen sc1
    s_sub_u32 s66, s66, 1
    s_cbranch_scc1 p_kernel_gud7_0
    s_waitcnt vmcnt(0)
    v_cmp_eq_u32 vcc, -1, v32
    s_cbranch_vccnz p_kernel_rtd7_0
    s_branch p_kernel_rbd7_0

p_kernel_gud7_0:
    s_mov_b32 s66, 0
    s_waitcnt vmcnt(0)
    s_branch p_kernel_rbd7_0

p_kernel_rtd7_1:
    s_sleep 2
    buffer_load_dwordx4 v[36:39], v117, s[32:35], 0 offen sc1
    s_sub_u32 s66, s66, 1
    s_cbranch_scc1 p_kernel_gud7_1
    s_waitcnt vmcnt(0)
    v_cmp_eq_u32 vcc, -1, v36
    s_cbranch_vccnz p_kernel_rtd7_1
    s_branch p_kernel_rbd7_1

p_kernel_gud7_1:
    s_mov_b32 s66, 0
    s_waitcnt vmcnt(0)
    s_branch p_kernel_rbd7_1

p_kernel_rtd7_2:
    s_sleep 2
    buffer_load_dwordx4 v[40:43], v118, s[32:35], 0 offen sc1
    s_sub_u32 s66, s66, 1
    s_cbranch_scc1 p_kernel_gud7_2
    s_waitcnt vmcnt(0)
    v_cmp_eq_u32 vcc, -1, v40
    s_cbranch_vccnz p_kernel_rtd7_2
    s_branch p_kernel_rbd7_2

p_kernel_gud7_2:
    s_mov_b32 s66, 0
    s_waitcnt vmcnt(0)
    s_branch p_kernel_rbd7_2

p_kernel_done:
    s_waitcnt lgkmcnt(0)
    s_branch p_kernel_epi
p_kernel_slow:
    s_cmp_eq_u32 s67, 1
    s_cbranch_scc1 p_kernel_nost2
    s_lshl_b32 s62, s67, 2
    s_sub_u32 s62, s62, 4

    v_dot2_f32_bf16 v65, v84, s70, 0
    v_dot2_f32_bf16 v66, v84, v84, 0
    v_dot2_f32_bf16 v65, v85, s70, v65
    v_dot2_f32_bf16 v66, v85, v85, v66
    v_dot2_f32_bf16 v65, v86, s70, v65
    v_dot2_f32_bf16 v66, v86, v86, v66
    v_dot2_f32_bf16 v65, v87, s70, v65
    v_dot2_f32_bf16 v66, v87, v87, v66
    s_nop 1
    v_add_f32_dpp v65, v65, v65 quad_perm:[1,0,3,2] row_mask:0xf bank_mask:0xf
    v_add_f32_dpp v66, v66, v66 quad_perm:[1,0,3,2] row_mask:0xf bank_mask:0xf
    s_nop 0
    v_add_f32_dpp v65, v65, v65 quad_perm:[2,3,0,1] row_mask:0xf bank_mask:0xf
    v_add_f32_dpp v66, v66, v66 quad_perm:[2,3,0,1] row_mask:0xf bank_mask:0xf
    s_nop 0
    v_add_f32_dpp v65, v65, v65 row_half_mirror row_mask:0xf bank_mask:0xf
    v_add_f32_dpp v66, v66, v66 row_half_mirror row_mask:0xf bank_mask:0xf
    v_mul_f32 v65, 0x3c800000, v65
    v_mul_f32 v66, 0x3c800000, v66
    v_fma_f32 v67, -v65, v65, v66
    v_max_f32 v67, 0, v67
    v_add_f32 v67, 0x3727c5ac, v67
    v_rsq_f32 v64, v67

    v_add_u32 v68, s62, v29
    s_mov_b64 exec, s[68:69]
    ds_write_b32 v68, v64
    s_mov_b64 exec, -1

p_kernel_nost2:
    v_lshlrev_b32 v64, 4, v96
    v_add_u32 v64, 138240, v64
    v_mov_b32 v68, 0
    v_mov_b32 v69, 0
    v_mov_b32 v70, 0
    v_mov_b32 v71, 0

    v_cmp_gt_u32 vcc, 1024, v96
    s_and_saveexec_b64 s[60:61], vcc
    ds_write_b128 v64, v[68:71] offset:0
    s_mov_b64 exec, s[60:61]

    v_cmp_gt_u32 vcc, 576, v96
    s_and_saveexec_b64 s[60:61], vcc
    ds_write_b128 v64, v[68:71] offset:16384
    s_mov_b64 exec, s[60:61]

    s_waitcnt lgkmcnt(0)
    s_barrier
    v_lshlrev_b32 v64, 2, v96
    s_mov_b32 s62, 0

p_kernel_sl_loop:
    buffer_load_dword v65, v64, s[28:31], s62 offen
    buffer_load_dword v66, v64, s[24:27], s62 offen
    v_add_u32 v67, s62, v64
    s_waitcnt vmcnt(0)
    v_subrev_u32 v65, s44, v65
    v_cmp_gt_u32 vcc, 100, v65
    s_mov_b64 s[64:65], vcc
    v_cmp_gt_u32 vcc, 3200000, v67
    s_and_b64 vcc, vcc, s[64:65]
    s_and_saveexec_b64 s[60:61], vcc
    s_cbranch_execz p_kernel_sl_next
    v_lshrrev_b32 v68, 2, v65
    v_lshlrev_b32 v68, 10, v68
    v_bfe_u32 v69, v65, 1, 1
    v_lshl_add_u32 v68, v69, 9, v68
    v_and_b32 v69, 1, v65
    v_lshl_add_u32 v68, v69, 7, v68
    v_add_u32 v68, 138240, v68
    v_lshlrev_b32 v66, 7, v66

p_kernel_sl_rt:
    buffer_load_dwordx4 v[32:35], v66, s[32:35], 0 offen offset:0 sc1
    buffer_load_dwordx4 v[36:39], v66, s[32:35], 0 offen offset:16 sc1
    buffer_load_dwordx4 v[40:43], v66, s[32:35], 0 offen offset:32 sc1
    buffer_load_dwordx4 v[44:47], v66, s[32:35], 0 offen offset:48 sc1
    buffer_load_dwordx4 v[48:51], v66, s[32:35], 0 offen offset:64 sc1
    buffer_load_dwordx4 v[52:55], v66, s[32:35], 0 offen offset:80 sc1
    buffer_load_dwordx4 v[56:59], v66, s[32:35], 0 offen offset:96 sc1
    buffer_load_dwordx4 v[60:63], v66, s[32:35], 0 offen offset:112 sc1
    s_waitcnt vmcnt(0)
    v_cmp_eq_u32 s[64:65], -1, v32
    v_cmp_eq_u32 vcc, -1, v36
    s_or_b64 s[64:65], s[64:65], vcc
    v_cmp_eq_u32 vcc, -1, v40
    s_or_b64 s[64:65], s[64:65], vcc
    v_cmp_eq_u32 vcc, -1, v44
    s_or_b64 s[64:65], s[64:65], vcc
    v_cmp_eq_u32 vcc, -1, v48
    s_or_b64 s[64:65], s[64:65], vcc
    v_cmp_eq_u32 vcc, -1, v52
    s_or_b64 s[64:65], s[64:65], vcc
    v_cmp_eq_u32 vcc, -1, v56
    s_or_b64 s[64:65], s[64:65], vcc
    v_cmp_eq_u32 vcc, -1, v60
    s_or_b64 s[64:65], s[64:65], vcc
    s_cmp_eq_u64 s[64:65], 0
    s_cbranch_scc1 p_kernel_sl_ok
    s_sleep 2
    s_sub_u32 s66, s66, 1
    s_cbranch_scc0 p_kernel_sl_rt
    s_mov_b32 s66, 0

p_kernel_sl_ok:
    v_lshlrev_b32 v70, 16, v32
    v_and_b32 v71, 0xffff0000, v32
    ds_add_f32 v68, v70 offset:0
    ds_add_f32 v68, v71 offset:4

    v_lshlrev_b32 v70, 16, v33
    v_and_b32 v71, 0xffff0000, v33
    ds_add_f32 v68, v70 offset:8
    ds_add_f32 v68, v71 offset:12

    v_lshlrev_b32 v70, 16, v34
    v_and_b32 v71, 0xffff0000, v34
    ds_add_f32 v68, v70 offset:256
    ds_add_f32 v68, v71 offset:260

    v_lshlrev_b32 v70, 16, v35
    v_and_b32 v71, 0xffff0000, v35
    ds_add_f32 v68, v70 offset:264
    ds_add_f32 v68, v71 offset:268

    v_lshlrev_b32 v70, 16, v36
    v_and_b32 v71, 0xffff0000, v36
    ds_add_f32 v68, v70 offset:16
    ds_add_f32 v68, v71 offset:20

    v_lshlrev_b32 v70, 16, v37
    v_and_b32 v71, 0xffff0000, v37
    ds_add_f32 v68, v70 offset:24
    ds_add_f32 v68, v71 offset:28

    v_lshlrev_b32 v70, 16, v38
    v_and_b32 v71, 0xffff0000, v38
    ds_add_f32 v68, v70 offset:272
    ds_add_f32 v68, v71 offset:276

    v_lshlrev_b32 v70, 16, v39
    v_and_b32 v71, 0xffff0000, v39
    ds_add_f32 v68, v70 offset:280
    ds_add_f32 v68, v71 offset:284

    v_lshlrev_b32 v70, 16, v40
    v_and_b32 v71, 0xffff0000, v40
    ds_add_f32 v68, v70 offset:32
    ds_add_f32 v68, v71 offset:36

    v_lshlrev_b32 v70, 16, v41
    v_and_b32 v71, 0xffff0000, v41
    ds_add_f32 v68, v70 offset:40
    ds_add_f32 v68, v71 offset:44

    v_lshlrev_b32 v70, 16, v42
    v_and_b32 v71, 0xffff0000, v42
    ds_add_f32 v68, v70 offset:288
    ds_add_f32 v68, v71 offset:292

    v_lshlrev_b32 v70, 16, v43
    v_and_b32 v71, 0xffff0000, v43
    ds_add_f32 v68, v70 offset:296
    ds_add_f32 v68, v71 offset:300

    v_lshlrev_b32 v70, 16, v44
    v_and_b32 v71, 0xffff0000, v44
    ds_add_f32 v68, v70 offset:48
    ds_add_f32 v68, v71 offset:52

    v_lshlrev_b32 v70, 16, v45
    v_and_b32 v71, 0xffff0000, v45
    ds_add_f32 v68, v70 offset:56
    ds_add_f32 v68, v71 offset:60

    v_lshlrev_b32 v70, 16, v46
    v_and_b32 v71, 0xffff0000, v46
    ds_add_f32 v68, v70 offset:304
    ds_add_f32 v68, v71 offset:308

    v_lshlrev_b32 v70, 16, v47
    v_and_b32 v71, 0xffff0000, v47
    ds_add_f32 v68, v70 offset:312
    ds_add_f32 v68, v71 offset:316

    v_lshlrev_b32 v70, 16, v48
    v_and_b32 v71, 0xffff0000, v48
    ds_add_f32 v68, v70 offset:64
    ds_add_f32 v68, v71 offset:68

    v_lshlrev_b32 v70, 16, v49
    v_and_b32 v71, 0xffff0000, v49
    ds_add_f32 v68, v70 offset:72
    ds_add_f32 v68, v71 offset:76

    v_lshlrev_b32 v70, 16, v50
    v_and_b32 v71, 0xffff0000, v50
    ds_add_f32 v68, v70 offset:320
    ds_add_f32 v68, v71 offset:324

    v_lshlrev_b32 v70, 16, v51
    v_and_b32 v71, 0xffff0000, v51
    ds_add_f32 v68, v70 offset:328
    ds_add_f32 v68, v71 offset:332

    v_lshlrev_b32 v70, 16, v52
    v_and_b32 v71, 0xffff0000, v52
    ds_add_f32 v68, v70 offset:80
    ds_add_f32 v68, v71 offset:84

    v_lshlrev_b32 v70, 16, v53
    v_and_b32 v71, 0xffff0000, v53
    ds_add_f32 v68, v70 offset:88
    ds_add_f32 v68, v71 offset:92

    v_lshlrev_b32 v70, 16, v54
    v_and_b32 v71, 0xffff0000, v54
    ds_add_f32 v68, v70 offset:336
    ds_add_f32 v68, v71 offset:340

    v_lshlrev_b32 v70, 16, v55
    v_and_b32 v71, 0xffff0000, v55
    ds_add_f32 v68, v70 offset:344
    ds_add_f32 v68, v71 offset:348

    v_lshlrev_b32 v70, 16, v56
    v_and_b32 v71, 0xffff0000, v56
    ds_add_f32 v68, v70 offset:96
    ds_add_f32 v68, v71 offset:100

    v_lshlrev_b32 v70, 16, v57
    v_and_b32 v71, 0xffff0000, v57
    ds_add_f32 v68, v70 offset:104
    ds_add_f32 v68, v71 offset:108

    v_lshlrev_b32 v70, 16, v58
    v_and_b32 v71, 0xffff0000, v58
    ds_add_f32 v68, v70 offset:352
    ds_add_f32 v68, v71 offset:356

    v_lshlrev_b32 v70, 16, v59
    v_and_b32 v71, 0xffff0000, v59
    ds_add_f32 v68, v70 offset:360
    ds_add_f32 v68, v71 offset:364

    v_lshlrev_b32 v70, 16, v60
    v_and_b32 v71, 0xffff0000, v60
    ds_add_f32 v68, v70 offset:112
    ds_add_f32 v68, v71 offset:116

    v_lshlrev_b32 v70, 16, v61
    v_and_b32 v71, 0xffff0000, v61
    ds_add_f32 v68, v70 offset:120
    ds_add_f32 v68, v71 offset:124

    v_lshlrev_b32 v70, 16, v62
    v_and_b32 v71, 0xffff0000, v62
    ds_add_f32 v68, v70 offset:368
    ds_add_f32 v68, v71 offset:372

    v_lshlrev_b32 v70, 16, v63
    v_and_b32 v71, 0xffff0000, v63
    ds_add_f32 v68, v70 offset:376
    ds_add_f32 v68, v71 offset:380

p_kernel_sl_next:
    s_mov_b64 exec, s[60:61]
    s_add_u32 s62, s62, 4096
    s_cmp_lt_u32 s62, 3200000
    s_cbranch_scc1 p_kernel_sl_loop
    s_waitcnt lgkmcnt(0)
    s_barrier
    s_cmp_ge_u32 s3, 13
    s_cbranch_scc1 p_kernel_sl_done
    v_lshlrev_b32 v64, 4, v0
    v_add_u32 v64, 138240, v64
    s_lshl_b32 s62, s3, 10
    v_add_u32 v65, s62, v64
    ds_read_b128 v[16:19], v65
    s_sub_u32 s62, 25, s3
    s_min_u32 s62, s62, 24
    s_lshl_b32 s62, s62, 10
    v_add_u32 v65, s62, v64
    ds_read_b128 v[12:15], v65
    s_waitcnt lgkmcnt(0)

p_kernel_sl_done:
    s_cmp_ge_u32 s3, 13
    s_cbranch_scc1 p_kernel_hopend

p_kernel_epi:
    s_nop 4
    v_mul_f32 v66, v16, v7
    v_mul_f32 v67, v17, v7
    v_mul_f32 v68, v18, v7
    v_mul_f32 v69, v19, v7
    v_mul_f32 v70, v12, v28
    v_mul_f32 v71, v13, v28
    v_mul_f32 v72, v14, v28
    v_mul_f32 v73, v15, v28
    s_cmp_eq_u32 s67, 7
    s_cbranch_scc1 p_kernel_nog

    v_mul_f32 v76, v66, v7
    v_mul_f32 v77, v67, v7
    v_mul_f32 v78, v68, v7
    v_mul_f32 v79, v69, v7
    v_mul_f32 v80, v70, v28
    v_mul_f32 v81, v71, v28
    v_mul_f32 v82, v72, v28
    v_mul_f32 v83, v73, v28
    v_cvt_pk_bf16_f32 v88, v76, v77
    v_cvt_pk_bf16_f32 v89, v78, v79
    v_cvt_pk_bf16_f32 v90, v80, v81
    v_cvt_pk_bf16_f32 v91, v82, v83
    s_nop 0
    v_permlane16_swap_b32 v88, v90
    v_permlane16_swap_b32 v89, v91
    v_min_u32 v88, 0xfffffffe, v88
    buffer_store_dwordx4 v[88:91], v5, s[40:43], 0 offen sc1

p_kernel_nog:
    v_cvt_pk_bf16_f32 v84, v66, v67
    v_cvt_pk_bf16_f32 v85, v68, v69
    v_cvt_pk_bf16_f32 v86, v70, v71
    v_cvt_pk_bf16_f32 v87, v72, v73
    s_lshl_b32 s62, s67, 4
    s_lshl_b32 s63, s67, 7
    v_xor_b32 v74, s62, v1
    v_add3_u32 v74, v74, s63, v6
    v_permlane16_swap_b32 v84, v86
    v_permlane16_swap_b32 v85, v87
    s_mov_b64 exec, s[68:69]
    ds_write_b128 v74, v[84:87]
    s_mov_b64 exec, -1

    s_cmp_lg_u32 s67, 1
    s_cbranch_scc1 p_kernel_hopend
    s_cmp_lg_u32 s3, 0
    s_cbranch_scc1 p_kernel_hopend
    s_mov_b32 s63, 1

    v_lshrrev_b32 v65, 1, v0
    v_lshlrev_b32 v65, 8, v65
    v_and_b32 v66, 1, v0
    v_lshl_add_u32 v65, v66, 4, v65
    s_mov_b32 s62, 13631488

p_kernel_pollz:
    buffer_load_dwordx4 v[68:71], v65, s[12:15], s62 offen sc1
    s_waitcnt vmcnt(0)
    v_min_u32 v68, v68, v69
    v_min3_u32 v68, v68, v70, v71
    v_cmp_gt_u32 vcc, s63, v68
    s_cbranch_vccz p_kernel_hopend
    s_sleep 32
    s_sub_u32 s66, s66, 1
    s_cbranch_scc0 p_kernel_pollz
    s_mov_b32 s66, 0
    s_branch p_kernel_hopend

p_kernel_hopend:
    s_cmp_eq_u32 s67, 7
    s_cbranch_scc1 p_kernel_fin
    s_waitcnt lgkmcnt(0)
    s_barrier
    s_add_u32 s67, s67, 1
    s_add_u32 s32, s32, 4194304
    s_addc_u32 s33, s33, 0
    s_add_u32 s40, s40, 4194304
    s_addc_u32 s41, s41, 0
    s_branch p_kernel_hop

p_kernel_fin:
    s_cmp_ge_u32 s3, 13
    s_cbranch_scc1 p_kernel_fsp
    s_mov_b32 s62, 28

    v_dot2_f32_bf16 v65, v84, s70, 0
    v_dot2_f32_bf16 v66, v84, v84, 0
    v_dot2_f32_bf16 v65, v85, s70, v65
    v_dot2_f32_bf16 v66, v85, v85, v66
    v_dot2_f32_bf16 v65, v86, s70, v65
    v_dot2_f32_bf16 v66, v86, v86, v66
    v_dot2_f32_bf16 v65, v87, s70, v65
    v_dot2_f32_bf16 v66, v87, v87, v66
    s_nop 1
    v_add_f32_dpp v65, v65, v65 quad_perm:[1,0,3,2] row_mask:0xf bank_mask:0xf
    v_add_f32_dpp v66, v66, v66 quad_perm:[1,0,3,2] row_mask:0xf bank_mask:0xf
    s_nop 0
    v_add_f32_dpp v65, v65, v65 quad_perm:[2,3,0,1] row_mask:0xf bank_mask:0xf
    v_add_f32_dpp v66, v66, v66 quad_perm:[2,3,0,1] row_mask:0xf bank_mask:0xf
    s_nop 0
    v_add_f32_dpp v65, v65, v65 row_half_mirror row_mask:0xf bank_mask:0xf
    v_add_f32_dpp v66, v66, v66 row_half_mirror row_mask:0xf bank_mask:0xf
    v_mul_f32 v65, 0x3c800000, v65
    v_mul_f32 v66, 0x3c800000, v66
    v_fma_f32 v67, -v65, v65, v66
    v_max_f32 v67, 0, v67
    v_add_f32 v67, 0x3727c5ac, v67
    v_rsq_f32 v64, v67

    v_add_u32 v68, s62, v29
    s_mov_b64 exec, s[68:69]
    ds_write_b32 v68, v64
    s_mov_b64 exec, -1

    s_lshl_b32 s62, s3, 2
    s_add_u32 s62, s62, 137792
    v_mov_b32 v68, s62
    s_waitcnt lgkmcnt(0)
    ds_write_b32 v68, v124

p_kernel_fsp:
    v_lshlrev_b32 v8, 4, v0
    v_add_u32 v8, 115712, v8
    ds_read_b128 v[32:35], v8 offset:16384
    ds_read_b128 v[36:39], v8 offset:17408
    v_lshrrev_b32 v105, 4, v0
    v_and_b32 v106, 15, v0
    v_lshrrev_b32 v107, 5, v0
    v_lshlrev_b32 v107, 3, v107
    v_add_u32 v125, 137344, v107
    v_lshlrev_b32 v107, 2, v105
    v_sub_u32 v107, v106, v107
    v_mov_b32 v108, 0x3f80
    v_mov_b32 v109, 0x3f800000
    v_cmp_eq_u32 vcc, 0, v107
    s_nop 1
    v_cndmask_b32 v22, 0, v108, vcc
    v_cmp_eq_u32 vcc, 1, v107
    s_nop 1
    v_cndmask_b32 v22, v22, v109, vcc
    v_cmp_eq_u32 vcc, 2, v107
    s_nop 1
    v_cndmask_b32 v23, 0, v108, vcc
    v_cmp_eq_u32 vcc, 3, v107
    s_nop 1
    v_cndmask_b32 v23, v23, v109, vcc
    v_lshrrev_b32 v107, 5, v0
    v_bfe_u32 v108, v0, 3, 1
    v_cmp_eq_u32 vcc, v107, v108
    s_nop 1
    v_cndmask_b32 v3, 0, v109, vcc
    v_lshlrev_b32 v2, 4, v105
    v_and_b32 v107, 7, v0
    v_xor_b32 v108, v105, v107
    v_lshlrev_b32 v108, 4, v108
    v_lshl_add_u32 v4, v106, 7, v108
    v_xor_b32 v5, 64, v4
    v_bfe_u32 v107, v0, 2, 2
    v_lshl_add_u32 v107, v105, 2, v107
    v_and_b32 v108, 7, v107
    v_and_b32 v109, 3, v0
    v_xor_b32 v108, v108, v109
    v_lshlrev_b32 v108, 4, v108
    v_lshl_add_u32 v6, v107, 7, v108
    v_xor_b32 v7, 64, v6
    s_mov_b32 s63, 134144
    v_lshl_add_u32 v9, v106, 2, s63
    v_lshl_add_u32 v10, v105, 4, s63
    v_and_b32 v107, 31, v0
    v_lshlrev_b32 v126, 2, v107

    s_mov_b32 s41, 0x3c800000
    s_mov_b32 s78, 0
    s_mov_b32 s80, 0
    s_lshl_b32 s62, s3, 1
    s_add_u32 s63, s62, 1
    s_lshl_b32 s63, s63, 8
    s_or_b32 s77, s62, s63
    s_sub_u32 s63, 50, s62
    s_lshl_b32 s63, s63, 16
    s_or_b32 s77, s77, s63
    s_sub_u32 s63, 51, s62
    s_lshl_b32 s63, s63, 24
    s_or_b32 s77, s77, s63
    s_mov_b32 s79, 3
    s_cmp_eq_u32 s3, 1
    s_cselect_b32 s79, 4, s79
    s_cmp_lg_u32 s3, 0
    s_cbranch_scc1 p_kernel_fs1
    s_mov_b32 s77, 454885632
    s_mov_b32 s79, 4

p_kernel_fs1:
    s_cmp_lt_u32 s3, 13
    s_cbranch_scc1 p_kernel_fs2
    s_sub_u32 s62, 73, s62
    s_sub_u32 s63, s62, 6
    s_lshl_b32 s63, s63, 8
    s_or_b32 s77, s62, s63
    s_sub_u32 s63, s62, 12
    s_lshl_b32 s63, s63, 16
    s_or_b32 s77, s77, s63

p_kernel_fs2:
    s_setprio 2
p_kernel_floop:
    s_and_b32 s62, s77, 0xff
    s_lshr_b32 s77, s77, 8
    s_lshr_b32 s63, s62, 1
    s_sub_u32 s64, 25, s63
    s_cmp_gt_u32 s63, 12
    s_cselect_b32 s64, s64, s63
    s_cselect_b32 s65, 4, 0
    s_and_b32 s63, s62, 1
    s_lshl_b32 s63, s63, 4
    s_add_u32 s65, s65, s63
    s_lshl_b32 s63, s64, 5
    s_add_u32 s65, s65, s63
    v_add_u32 v107, s65, v125
    ds_read_b32 v124, v107
    s_sub_u32 s63, s62, s80
    s_mov_b32 s80, s62
    s_lshl_b32 s62, s63, 11
    s_lshl_b32 s63, s63, 6
    v_add_u32 v4, s62, v4
    v_add_u32 v5, s62, v5
    v_add_u32 v6, s62, v6
    v_add_u32 v7, s62, v7
    v_add_u32 v9, s63, v9
    v_add_u32 v10, s63, v10
    s_cmp_eq_u32 s64, s3
    s_cbranch_scc1 p_kernel_fgo
    s_lshl_b32 s64, s64, 2
    s_add_u32 s64, s64, 137792
    v_mov_b32 v108, s64

p_kernel_fpoll:
    ds_read_b32 v109, v108
    s_waitcnt lgkmcnt(0)
    v_readfirstlane_b32 s62, v109
    s_cmp_lg_u32 s62, 0
    s_cbranch_scc1 p_kernel_fgo
    s_sleep 3
    s_sub_u32 s66, s66, 1
    s_cbranch_scc0 p_kernel_fpoll
    s_mov_b32 s66, 0

p_kernel_fgo:
    ds_read_b128 v[12:15], v4
    ds_read_b128 v[16:19], v5

    ds_read_b128 v[40:43], v8 offset:0
    ds_read_b128 v[44:47], v8 offset:1024
    ds_read_b128 v[48:51], v8 offset:2048
    ds_read_b128 v[52:55], v8 offset:3072
    ds_read_b32 v104, v9
    ds_read_b128 v[108:111], v10
    ds_read_b64_tr_b16 v[74:75], v6
    ds_read_b64_tr_b16 v[78:79], v6 offset:8
    ds_read_b64_tr_b16 v[82:83], v7
    ds_read_b64_tr_b16 v[86:87], v7 offset:8
    s_waitcnt lgkmcnt(8)

    v_mfma_f32_16x16x32_bf16 v[56:59], v[40:43], v[12:15], 0
    v_mfma_f32_16x16x32_bf16 v[56:59], v[44:47], v[16:19], v[56:59]
    s_waitcnt lgkmcnt(6)
    v_mfma_f32_16x16x32_bf16 v[60:63], v[48:51], v[12:15], 0
    v_mfma_f32_16x16x32_bf16 v[60:63], v[52:55], v[16:19], v[60:63]
    ds_read_b128 v[40:43], v8 offset:4096
    ds_read_b128 v[44:47], v8 offset:5120
    ds_read_b128 v[48:51], v8 offset:6144
    ds_read_b128 v[52:55], v8 offset:7168
    s_waitcnt lgkmcnt(2)
    v_mfma_f32_16x16x32_bf16 v[64:67], v[40:43], v[12:15], 0
    v_mfma_f32_16x16x32_bf16 v[64:67], v[44:47], v[16:19], v[64:67]
    s_waitcnt lgkmcnt(0)
    v_mfma_f32_16x16x32_bf16 v[68:71], v[48:51], v[12:15], 0
    v_mfma_f32_16x16x32_bf16 v[68:71], v[52:55], v[16:19], v[68:71]
    ds_read_b128 v[40:43], v8 offset:8192
    ds_read_b128 v[44:47], v8 offset:9216
    ds_read_b128 v[48:51], v8 offset:10240
    ds_read_b128 v[52:55], v8 offset:11264
    v_mul_f32 v114, v108, v104
    v_mul_f32 v115, v109, v104
    v_mul_f32 v116, v110, v104
    v_mul_f32 v117, v111, v104
    v_cvt_pk_bf16_f32 v88, v56, v57
    v_cvt_pk_bf16_f32 v89, v58, v59
    v_cvt_pk_bf16_f32 v90, v60, v61
    v_cvt_pk_bf16_f32 v91, v62, v63
    v_cvt_pk_bf16_f32 v92, v64, v65
    v_cvt_pk_bf16_f32 v93, v66, v67
    v_cvt_pk_bf16_f32 v94, v68, v69
    v_cvt_pk_bf16_f32 v95, v70, v71
    v_mfma_f32_16x16x32_bf16 v[24:27], v[88:91], v[12:15], 0
    s_nop 0
    v_mfma_f32_16x16x32_bf16 v[24:27], v[92:95], v[16:19], v[24:27]
    s_waitcnt lgkmcnt(2)
    v_mfma_f32_16x16x32_bf16 v[56:59], v[12:15], v[40:43], 0
    v_mfma_f32_16x16x32_bf16 v[56:59], v[16:19], v[44:47], v[56:59]
    s_waitcnt lgkmcnt(0)
    v_mfma_f32_16x16x32_bf16 v[60:63], v[12:15], v[48:51], 0
    v_mfma_f32_16x16x32_bf16 v[60:63], v[16:19], v[52:55], v[60:63]
    ds_read_b128 v[40:43], v8 offset:12288
    ds_read_b128 v[44:47], v8 offset:13312
    ds_read_b128 v[48:51], v8 offset:14336
    ds_read_b128 v[52:55], v8 offset:15360
    v_mul_f32 v24, v24, v114
    v_mul_f32 v25, v25, v115
    v_mul_f32 v26, v26, v116
    v_mul_f32 v27, v27, v117
    v_max3_f32 v112, v24, v25, v26
    v_max_f32 v112, v112, v27

    v_mov_b32 v106, v112
    s_nop 1
    v_permlane16_swap_b32 v106, v112
    v_max_f32 v112, v112, v106

    s_waitcnt lgkmcnt(2)
    v_mfma_f32_16x16x32_bf16 v[64:67], v[12:15], v[40:43], 0
    v_mfma_f32_16x16x32_bf16 v[64:67], v[16:19], v[44:47], v[64:67]
    s_waitcnt lgkmcnt(0)
    v_mfma_f32_16x16x32_bf16 v[68:71], v[12:15], v[48:51], 0
    v_mfma_f32_16x16x32_bf16 v[68:71], v[16:19], v[52:55], v[68:71]
    v_sub_f32 v24, v24, v112
    v_sub_f32 v25, v25, v112
    v_sub_f32 v26, v26, v112
    v_sub_f32 v27, v27, v112
    v_exp_f32 v24, v24
    v_exp_f32 v25, v25
    v_exp_f32 v26, v26
    v_exp_f32 v27, v27
    v_add_f32 v113, v24, v25
    v_add_f32 v106, v26, v27
    v_add_f32 v113, v113, v106

    v_mov_b32 v106, v113
    s_nop 1
    v_permlane16_swap_b32 v106, v113
    v_add_f32 v113, v113, v106

    v_rcp_f32 v113, v113
    s_nop 0
    v_mul_f32 v113, v113, v3

    v_mul_f32 v114, v113, v108
    v_mul_f32 v115, v113, v109
    v_mul_f32 v116, v113, v110
    v_mul_f32 v117, v113, v111
    v_cvt_pk_bf16_f32 v72, v56, v57
    v_cvt_pk_bf16_f32 v73, v58, v59
    v_cvt_pk_bf16_f32 v76, v60, v61
    v_cvt_pk_bf16_f32 v77, v62, v63
    v_cvt_pk_bf16_f32 v80, v64, v65
    v_cvt_pk_bf16_f32 v81, v66, v67
    v_cvt_pk_bf16_f32 v84, v68, v69
    v_cvt_pk_bf16_f32 v85, v70, v71
    v_mul_f32 v24, v24, v114
    v_mul_f32 v25, v25, v115
    v_mul_f32 v26, v26, v116
    v_mul_f32 v27, v27, v117
    v_cvt_pk_bf16_f32 v20, v24, v25
    v_cvt_pk_bf16_f32 v21, v26, v27
    s_nop 1
    v_mfma_f32_16x16x32_bf16 v[56:59], v[72:75], v[20:23], 0
    v_mfma_f32_16x16x32_bf16 v[60:63], v[76:79], v[20:23], 0
    v_mfma_f32_16x16x32_bf16 v[64:67], v[80:83], v[20:23], 0
    v_mfma_f32_16x16x32_bf16 v[68:71], v[84:87], v[20:23], 0
    v_mfma_f32_16x16x32_bf16 v[88:91], v[20:23], v[72:75], 0
    v_mfma_f32_16x16x32_bf16 v[92:95], v[20:23], v[76:79], 0
    v_mfma_f32_16x16x32_bf16 v[96:99], v[20:23], v[80:83], 0
    v_mfma_f32_16x16x32_bf16 v[100:103], v[20:23], v[84:87], 0
    s_nop 1
    v_cvt_pk_bf16_f32 v12, v56, v60
    v_cvt_pk_bf16_f32 v13, v57, v61
    v_cvt_pk_bf16_f32 v14, v58, v62
    v_cvt_pk_bf16_f32 v15, v59, v63
    v_cvt_pk_bf16_f32 v16, v64, v68
    v_cvt_pk_bf16_f32 v17, v65, v69
    v_cvt_pk_bf16_f32 v18, v66, v70
    v_cvt_pk_bf16_f32 v19, v67, v71
    v_mfma_f32_16x16x32_bf16 v[28:31], v[32:35], v[12:15], 0
    s_nop 0
    v_mfma_f32_16x16x32_bf16 v[28:31], v[36:39], v[16:19], v[28:31]
    v_dot2_f32_bf16 v105, v12, v12, 0
    v_dot2_f32_bf16 v105, v13, v13, v105
    v_dot2_f32_bf16 v105, v14, v14, v105
    v_dot2_f32_bf16 v105, v15, v15, v105
    v_dot2_f32_bf16 v105, v16, v16, v105
    v_dot2_f32_bf16 v105, v17, v17, v105
    v_dot2_f32_bf16 v105, v18, v18, v105
    v_dot2_f32_bf16 v105, v19, v19, v105
    s_nop 2
    v_mov_b32 v106, v105
    s_nop 1
    v_permlane16_swap_b32 v106, v105
    v_add_f32 v105, v105, v106
    v_mov_b32 v106, v105
    s_nop 1
    v_permlane32_swap_b32 v106, v105
    v_add_f32 v105, v105, v106

    v_mul_f32 v107, 0x3c800000, v28
    v_mul_f32 v106, v107, v107
    v_fma_f32 v105, v105, s41, -v106
    v_max_f32 v105, 0, v105
    v_add_f32 v105, 0x3727c5ac, v105
    v_rsq_f32 v104, v105

    v_add_f32 v112, v29, v30
    v_mul_f32 v112, v112, v104
    v_mul_f32 v112, 0x3fb8aa3b, v112
    s_nop 1
    v_max_f32_dpp v106, v112, v112 quad_perm:[1,0,3,2] row_mask:0xf bank_mask:0xf
    s_nop 1
    v_max_f32_dpp v106, v106, v106 quad_perm:[2,3,0,1] row_mask:0xf bank_mask:0xf
    s_nop 1
    v_max_f32_dpp v106, v106, v106 row_half_mirror row_mask:0xf bank_mask:0xf
    v_sub_f32 v112, v112, v106
    v_exp_f32 v112, v112
    s_nop 1
    v_add_f32_dpp v106, v112, v112 quad_perm:[1,0,3,2] row_mask:0xf bank_mask:0xf
    s_nop 1
    v_add_f32_dpp v106, v106, v106 quad_perm:[2,3,0,1] row_mask:0xf bank_mask:0xf
    s_nop 1
    v_add_f32_dpp v106, v106, v106 row_half_mirror row_mask:0xf bank_mask:0xf
    v_rcp_f32 v106, v106
    s_nop 0
    v_mul_f32 v112, v112, v106

    ds_bpermute_b32 v114, v2, v112 offset:0
    ds_bpermute_b32 v115, v2, v112 offset:4
    ds_bpermute_b32 v116, v2, v112 offset:8
    ds_bpermute_b32 v117, v2, v112 offset:12
    s_waitcnt lgkmcnt(0)
    v_mul_f32 v118, v88, v114
    v_fmac_f32 v118, v89, v115
    v_fmac_f32 v118, v90, v116
    v_fmac_f32 v118, v91, v117
    v_mul_f32 v119, v92, v114
    v_fmac_f32 v119, v93, v115
    v_fmac_f32 v119, v94, v116
    v_fmac_f32 v119, v95, v117
    v_mul_f32 v120, v96, v114
    v_fmac_f32 v120, v97, v115
    v_fmac_f32 v120, v98, v116
    v_fmac_f32 v120, v99, v117
    v_mul_f32 v121, v100, v114
    v_fmac_f32 v121, v101, v115
    v_fmac_f32 v121, v102, v116
    v_fmac_f32 v121, v103, v117
    v_permlane16_swap_b32 v118, v120
    s_nop 0
    v_permlane16_swap_b32 v119, v121
    v_add_f32 v118, v118, v120
    v_add_f32 v119, v119, v121
    v_cvt_pk_bf16_f32 v123, v118, v119

    v_and_b32 v124, 0xffff, v124
    v_lshl_add_u32 v124, v124, 7, v126
    buffer_store_dword v123, v124, s[36:39], 0 offen

    s_add_u32 s78, s78, 1
    s_cmp_eq_u32 s78, 1
    s_cbranch_scc0 p_kernel_fp0
    s_setprio 1
    s_branch p_kernel_fp1

p_kernel_fp0:
    s_setprio 0
p_kernel_fp1:
    s_cmp_lt_u32 s78, s79
    s_cbranch_scc1 p_kernel_floop

    s_branch p_kernel_end
p_kernel_prep:
    s_load_dwordx4 s[4:7], s[0:1], 32
    s_load_dwordx4 s[8:11], s[0:1], 48
    s_load_dwordx2 s[44:45], s[0:1], 64
    s_load_dwordx2 s[46:47], s[0:1], 88
    s_load_dwordx2 s[58:59], s[0:1], 80
    v_mov_b32 v96, v0
    v_and_b32 v0, 63, v0
    v_lshrrev_b32 v1, 6, v96
    s_nop 0
    v_readfirstlane_b32 s3, v1
    v_lshrrev_b32 v2, 4, v0
    v_and_b32 v3, 15, v0
    s_lshr_b32 s48, s3, 2
    s_and_b32 s49, s3, 3
    v_lshlrev_b32 v4, 7, v3
    v_lshl_add_u32 v4, v2, 4, v4
    s_lshl_b32 s50, s48, 11
    s_lshl_b32 s51, s49, 11
    v_add_u32 v5, s50, v4
    v_add_u32 v6, s51, v4
    v_lshlrev_b32 v7, 10, v2
    v_lshl_add_u32 v7, v3, 1, v7
    s_lshl_b32 s52, s49, 5
    v_add_u32 v7, s52, v7
    s_waitcnt lgkmcnt(0)

    s_mov_b32 s12, s4
    s_mov_b32 s13, s5
    s_mov_b32 s14, 8192
    s_mov_b32 s15, 0x20000
    s_mov_b32 s16, s6
    s_mov_b32 s17, s7
    s_mov_b32 s18, 8192
    s_mov_b32 s19, 0x20000
    s_mov_b32 s20, s8
    s_mov_b32 s21, s9
    s_mov_b32 s22, 8192
    s_mov_b32 s23, 0x20000
    s_mov_b32 s24, s10
    s_mov_b32 s25, s11
    s_mov_b32 s26, 8192
    s_mov_b32 s27, 0x20000
    s_mov_b32 s28, s44
    s_mov_b32 s29, s45
    s_mov_b32 s30, 128
    s_mov_b32 s31, 0x20000
    s_mov_b32 s32, s46
    s_mov_b32 s33, s47
    s_mov_b32 s34, 50331648
    s_mov_b32 s35, 0x20000
    s_mov_b32 s60, s58
    s_mov_b32 s61, s59
    s_mov_b32 s62, 256
    s_mov_b32 s63, 0x20000
    buffer_load_dwordx4 v[8:11], v5, s[12:15], 0 offen
    buffer_load_dwordx4 v[12:15], v5, s[12:15], 0 offen offset:64
    buffer_load_dwordx4 v[16:19], v6, s[16:19], 0 offen
    buffer_load_dwordx4 v[20:23], v6, s[16:19], 0 offen offset:64
    buffer_load_dwordx4 v[24:27], v5, s[20:23], 0 offen
    buffer_load_dwordx4 v[28:31], v5, s[20:23], 0 offen offset:64

    s_mov_b32 s53, 0
    buffer_load_ushort v48, v7, s[24:27], s53 offen offset:0
    buffer_load_ushort v49, v7, s[24:27], s53 offen offset:128
    buffer_load_ushort v50, v7, s[24:27], s53 offen offset:256
    buffer_load_ushort v51, v7, s[24:27], s53 offen offset:384
    buffer_load_ushort v52, v7, s[24:27], s53 offen offset:512
    buffer_load_ushort v53, v7, s[24:27], s53 offen offset:640
    buffer_load_ushort v54, v7, s[24:27], s53 offen offset:768
    buffer_load_ushort v55, v7, s[24:27], s53 offen offset:896
    s_mov_b32 s53, 4096
    buffer_load_ushort v56, v7, s[24:27], s53 offen offset:0
    buffer_load_ushort v57, v7, s[24:27], s53 offen offset:128
    buffer_load_ushort v58, v7, s[24:27], s53 offen offset:256
    buffer_load_ushort v59, v7, s[24:27], s53 offen offset:384
    buffer_load_ushort v60, v7, s[24:27], s53 offen offset:512
    buffer_load_ushort v61, v7, s[24:27], s53 offen offset:640
    buffer_load_ushort v62, v7, s[24:27], s53 offen offset:768
    buffer_load_ushort v63, v7, s[24:27], s53 offen offset:896
    v_lshlrev_b32 v40, 1, v0
    buffer_load_ushort v41, v40, s[28:31], 0 offen
    s_waitcnt vmcnt(0)

    v_lshl_or_b32 v32, v49, 16, v48
    v_lshl_or_b32 v33, v51, 16, v50
    v_lshl_or_b32 v34, v53, 16, v52
    v_lshl_or_b32 v35, v55, 16, v54
    v_lshl_or_b32 v36, v57, 16, v56
    v_lshl_or_b32 v37, v59, 16, v58
    v_lshl_or_b32 v38, v61, 16, v60
    v_lshl_or_b32 v39, v63, 16, v62
    v_mfma_f32_16x16x32_bf16 v[44:47], v[8:11], v[16:19], 0
    v_mfma_f32_16x16x32_bf16 v[44:47], v[12:15], v[20:23], v[44:47]
    v_mfma_f32_16x16x32_bf16 v[48:51], v[24:27], v[32:35], 0
    v_mfma_f32_16x16x32_bf16 v[48:51], v[28:31], v[36:39], v[48:51]
    v_lshlrev_b32 v42, 10, v2
    v_lshl_add_u32 v42, v3, 2, v42
    s_lshl_b32 s50, s48, 12
    s_lshl_b32 s51, s49, 6
    s_add_u32 s50, s50, s51
    v_add_u32 v42, s50, v42

    ds_write_b32 v42, v44 offset:0
    s_nop 0
    ds_write_b32 v42, v48 offset:16384
    ds_write_b32 v42, v45 offset:256
    ds_write_b32 v42, v49 offset:16640
    ds_write_b32 v42, v46 offset:512
    ds_write_b32 v42, v50 offset:16896
    ds_write_b32 v42, v47 offset:768
    ds_write_b32 v42, v51 offset:17152
    v_lshlrev_b32 v41, 16, v41
    v_lshlrev_b32 v40, 2, v0
    s_cmp_lg_u32 s3, 0
    s_cbranch_scc1 p_kernel_p1
    ds_write_b32 v40, v41 offset:33536

p_kernel_p1:
    s_waitcnt lgkmcnt(0)
    s_barrier
    s_cmp_gt_u32 s3, 1
    s_cbranch_scc1 p_kernel_p2
    s_lshl_b32 s50, s3, 14
    v_add_u32 v43, s50, v40
    v_mov_b32 v44, 0

    ds_read_b32 v48, v43 offset:0
    ds_read_b32 v49, v43 offset:256
    ds_read_b32 v50, v43 offset:512
    ds_read_b32 v51, v43 offset:768
    ds_read_b32 v52, v43 offset:1024
    ds_read_b32 v53, v43 offset:1280
    ds_read_b32 v54, v43 offset:1536
    ds_read_b32 v55, v43 offset:1792
    ds_read_b32 v56, v43 offset:2048
    ds_read_b32 v57, v43 offset:2304
    ds_read_b32 v58, v43 offset:2560
    ds_read_b32 v59, v43 offset:2816
    ds_read_b32 v60, v43 offset:3072
    ds_read_b32 v61, v43 offset:3328
    ds_read_b32 v62, v43 offset:3584
    ds_read_b32 v63, v43 offset:3840
    s_waitcnt lgkmcnt(0)
    v_add_f32 v44, v44, v48
    v_add_f32 v44, v44, v49
    v_add_f32 v44, v44, v50
    v_add_f32 v44, v44, v51
    v_add_f32 v44, v44, v52
    v_add_f32 v44, v44, v53
    v_add_f32 v44, v44, v54
    v_add_f32 v44, v44, v55
    v_add_f32 v44, v44, v56
    v_add_f32 v44, v44, v57
    v_add_f32 v44, v44, v58
    v_add_f32 v44, v44, v59
    v_add_f32 v44, v44, v60
    v_add_f32 v44, v44, v61
    v_add_f32 v44, v44, v62
    v_add_f32 v44, v44, v63
    ds_read_b32 v48, v43 offset:4096
    ds_read_b32 v49, v43 offset:4352
    ds_read_b32 v50, v43 offset:4608
    ds_read_b32 v51, v43 offset:4864
    ds_read_b32 v52, v43 offset:5120
    ds_read_b32 v53, v43 offset:5376
    ds_read_b32 v54, v43 offset:5632
    ds_read_b32 v55, v43 offset:5888
    ds_read_b32 v56, v43 offset:6144
    ds_read_b32 v57, v43 offset:6400
    ds_read_b32 v58, v43 offset:6656
    ds_read_b32 v59, v43 offset:6912
    ds_read_b32 v60, v43 offset:7168
    ds_read_b32 v61, v43 offset:7424
    ds_read_b32 v62, v43 offset:7680
    ds_read_b32 v63, v43 offset:7936
    s_waitcnt lgkmcnt(0)
    v_add_f32 v44, v44, v48
    v_add_f32 v44, v44, v49
    v_add_f32 v44, v44, v50
    v_add_f32 v44, v44, v51
    v_add_f32 v44, v44, v52
    v_add_f32 v44, v44, v53
    v_add_f32 v44, v44, v54
    v_add_f32 v44, v44, v55
    v_add_f32 v44, v44, v56
    v_add_f32 v44, v44, v57
    v_add_f32 v44, v44, v58
    v_add_f32 v44, v44, v59
    v_add_f32 v44, v44, v60
    v_add_f32 v44, v44, v61
    v_add_f32 v44, v44, v62
    v_add_f32 v44, v44, v63
    ds_read_b32 v48, v43 offset:8192
    ds_read_b32 v49, v43 offset:8448
    ds_read_b32 v50, v43 offset:8704
    ds_read_b32 v51, v43 offset:8960
    ds_read_b32 v52, v43 offset:9216
    ds_read_b32 v53, v43 offset:9472
    ds_read_b32 v54, v43 offset:9728
    ds_read_b32 v55, v43 offset:9984
    ds_read_b32 v56, v43 offset:10240
    ds_read_b32 v57, v43 offset:10496
    ds_read_b32 v58, v43 offset:10752
    ds_read_b32 v59, v43 offset:11008
    ds_read_b32 v60, v43 offset:11264
    ds_read_b32 v61, v43 offset:11520
    ds_read_b32 v62, v43 offset:11776
    ds_read_b32 v63, v43 offset:12032
    s_waitcnt lgkmcnt(0)
    v_add_f32 v44, v44, v48
    v_add_f32 v44, v44, v49
    v_add_f32 v44, v44, v50
    v_add_f32 v44, v44, v51
    v_add_f32 v44, v44, v52
    v_add_f32 v44, v44, v53
    v_add_f32 v44, v44, v54
    v_add_f32 v44, v44, v55
    v_add_f32 v44, v44, v56
    v_add_f32 v44, v44, v57
    v_add_f32 v44, v44, v58
    v_add_f32 v44, v44, v59
    v_add_f32 v44, v44, v60
    v_add_f32 v44, v44, v61
    v_add_f32 v44, v44, v62
    v_add_f32 v44, v44, v63
    ds_read_b32 v48, v43 offset:12288
    ds_read_b32 v49, v43 offset:12544
    ds_read_b32 v50, v43 offset:12800
    ds_read_b32 v51, v43 offset:13056
    ds_read_b32 v52, v43 offset:13312
    ds_read_b32 v53, v43 offset:13568
    ds_read_b32 v54, v43 offset:13824
    ds_read_b32 v55, v43 offset:14080
    ds_read_b32 v56, v43 offset:14336
    ds_read_b32 v57, v43 offset:14592
    ds_read_b32 v58, v43 offset:14848
    ds_read_b32 v59, v43 offset:15104
    ds_read_b32 v60, v43 offset:15360
    ds_read_b32 v61, v43 offset:15616
    ds_read_b32 v62, v43 offset:15872
    ds_read_b32 v63, v43 offset:16128
    s_waitcnt lgkmcnt(0)
    v_add_f32 v44, v44, v48
    v_add_f32 v44, v44, v49
    v_add_f32 v44, v44, v50
    v_add_f32 v44, v44, v51
    v_add_f32 v44, v44, v52
    v_add_f32 v44, v44, v53
    v_add_f32 v44, v44, v54
    v_add_f32 v44, v44, v55
    v_add_f32 v44, v44, v56
    v_add_f32 v44, v44, v57
    v_add_f32 v44, v44, v58
    v_add_f32 v44, v44, v59
    v_add_f32 v44, v44, v60
    v_add_f32 v44, v44, v61
    v_add_f32 v44, v44, v62
    v_add_f32 v44, v44, v63
    v_mul_f32 v44, 0x3c800000, v44
    s_lshl_b32 s50, s3, 8
    v_add_u32 v43, s50, v40
    ds_write_b32 v43, v44 offset:32768

p_kernel_p2:
    s_waitcnt lgkmcnt(0)
    s_barrier
    s_cmp_gt_u32 s3, 1
    s_cbranch_scc1 p_kernel_p3
    s_cmp_eq_u32 s3, 1
    s_cbranch_scc1 p_kernel_p2b
    v_lshlrev_b32 v43, 8, v0
    v_mov_b32 v45, 0
    v_mov_b32 v44, 0

    ds_read_b128 v[48:51], v43 offset:0
    ds_read_b128 v[52:55], v45 offset:32768
    s_waitcnt lgkmcnt(0)
    v_sub_f32 v48, v48, v52
    v_sub_f32 v49, v49, v53
    v_sub_f32 v50, v50, v54
    v_sub_f32 v51, v51, v55
    v_add_f32 v44, v44, v48
    v_add_f32 v44, v44, v49
    v_add_f32 v44, v44, v50
    v_add_f32 v44, v44, v51

    ds_read_b128 v[48:51], v43 offset:16
    ds_read_b128 v[52:55], v45 offset:32784
    s_waitcnt lgkmcnt(0)
    v_sub_f32 v48, v48, v52
    v_sub_f32 v49, v49, v53
    v_sub_f32 v50, v50, v54
    v_sub_f32 v51, v51, v55
    v_add_f32 v44, v44, v48
    v_add_f32 v44, v44, v49
    v_add_f32 v44, v44, v50
    v_add_f32 v44, v44, v51

    ds_read_b128 v[48:51], v43 offset:32
    ds_read_b128 v[52:55], v45 offset:32800
    s_waitcnt lgkmcnt(0)
    v_sub_f32 v48, v48, v52
    v_sub_f32 v49, v49, v53
    v_sub_f32 v50, v50, v54
    v_sub_f32 v51, v51, v55
    v_add_f32 v44, v44, v48
    v_add_f32 v44, v44, v49
    v_add_f32 v44, v44, v50
    v_add_f32 v44, v44, v51

    ds_read_b128 v[48:51], v43 offset:48
    ds_read_b128 v[52:55], v45 offset:32816
    s_waitcnt lgkmcnt(0)
    v_sub_f32 v48, v48, v52
    v_sub_f32 v49, v49, v53
    v_sub_f32 v50, v50, v54
    v_sub_f32 v51, v51, v55
    v_add_f32 v44, v44, v48
    v_add_f32 v44, v44, v49
    v_add_f32 v44, v44, v50
    v_add_f32 v44, v44, v51

    ds_read_b128 v[48:51], v43 offset:64
    ds_read_b128 v[52:55], v45 offset:32832
    s_waitcnt lgkmcnt(0)
    v_sub_f32 v48, v48, v52
    v_sub_f32 v49, v49, v53
    v_sub_f32 v50, v50, v54
    v_sub_f32 v51, v51, v55
    v_add_f32 v44, v44, v48
    v_add_f32 v44, v44, v49
    v_add_f32 v44, v44, v50
    v_add_f32 v44, v44, v51

    ds_read_b128 v[48:51], v43 offset:80
    ds_read_b128 v[52:55], v45 offset:32848
    s_waitcnt lgkmcnt(0)
    v_sub_f32 v48, v48, v52
    v_sub_f32 v49, v49, v53
    v_sub_f32 v50, v50, v54
    v_sub_f32 v51, v51, v55
    v_add_f32 v44, v44, v48
    v_add_f32 v44, v44, v49
    v_add_f32 v44, v44, v50
    v_add_f32 v44, v44, v51

    ds_read_b128 v[48:51], v43 offset:96
    ds_read_b128 v[52:55], v45 offset:32864
    s_waitcnt lgkmcnt(0)
    v_sub_f32 v48, v48, v52
    v_sub_f32 v49, v49, v53
    v_sub_f32 v50, v50, v54
    v_sub_f32 v51, v51, v55
    v_add_f32 v44, v44, v48
    v_add_f32 v44, v44, v49
    v_add_f32 v44, v44, v50
    v_add_f32 v44, v44, v51

    ds_read_b128 v[48:51], v43 offset:112
    ds_read_b128 v[52:55], v45 offset:32880
    s_waitcnt lgkmcnt(0)
    v_sub_f32 v48, v48, v52
    v_sub_f32 v49, v49, v53
    v_sub_f32 v50, v50, v54
    v_sub_f32 v51, v51, v55
    v_add_f32 v44, v44, v48
    v_add_f32 v44, v44, v49
    v_add_f32 v44, v44, v50
    v_add_f32 v44, v44, v51

    ds_read_b128 v[48:51], v43 offset:128
    ds_read_b128 v[52:55], v45 offset:32896
    s_waitcnt lgkmcnt(0)
    v_sub_f32 v48, v48, v52
    v_sub_f32 v49, v49, v53
    v_sub_f32 v50, v50, v54
    v_sub_f32 v51, v51, v55
    v_add_f32 v44, v44, v48
    v_add_f32 v44, v44, v49
    v_add_f32 v44, v44, v50
    v_add_f32 v44, v44, v51

    ds_read_b128 v[48:51], v43 offset:144
    ds_read_b128 v[52:55], v45 offset:32912
    s_waitcnt lgkmcnt(0)
    v_sub_f32 v48, v48, v52
    v_sub_f32 v49, v49, v53
    v_sub_f32 v50, v50, v54
    v_sub_f32 v51, v51, v55
    v_add_f32 v44, v44, v48
    v_add_f32 v44, v44, v49
    v_add_f32 v44, v44, v50
    v_add_f32 v44, v44, v51

    ds_read_b128 v[48:51], v43 offset:160
    ds_read_b128 v[52:55], v45 offset:32928
    s_waitcnt lgkmcnt(0)
    v_sub_f32 v48, v48, v52
    v_sub_f32 v49, v49, v53
    v_sub_f32 v50, v50, v54
    v_sub_f32 v51, v51, v55
    v_add_f32 v44, v44, v48
    v_add_f32 v44, v44, v49
    v_add_f32 v44, v44, v50
    v_add_f32 v44, v44, v51

    ds_read_b128 v[48:51], v43 offset:176
    ds_read_b128 v[52:55], v45 offset:32944
    s_waitcnt lgkmcnt(0)
    v_sub_f32 v48, v48, v52
    v_sub_f32 v49, v49, v53
    v_sub_f32 v50, v50, v54
    v_sub_f32 v51, v51, v55
    v_add_f32 v44, v44, v48
    v_add_f32 v44, v44, v49
    v_add_f32 v44, v44, v50
    v_add_f32 v44, v44, v51

    ds_read_b128 v[48:51], v43 offset:192
    ds_read_b128 v[52:55], v45 offset:32960
    s_waitcnt lgkmcnt(0)
    v_sub_f32 v48, v48, v52
    v_sub_f32 v49, v49, v53
    v_sub_f32 v50, v50, v54
    v_sub_f32 v51, v51, v55
    v_add_f32 v44, v44, v48
    v_add_f32 v44, v44, v49
    v_add_f32 v44, v44, v50
    v_add_f32 v44, v44, v51

    ds_read_b128 v[48:51], v43 offset:208
    ds_read_b128 v[52:55], v45 offset:32976
    s_waitcnt lgkmcnt(0)
    v_sub_f32 v48, v48, v52
    v_sub_f32 v49, v49, v53
    v_sub_f32 v50, v50, v54
    v_sub_f32 v51, v51, v55
    v_add_f32 v44, v44, v48
    v_add_f32 v44, v44, v49
    v_add_f32 v44, v44, v50
    v_add_f32 v44, v44, v51

    ds_read_b128 v[48:51], v43 offset:224
    ds_read_b128 v[52:55], v45 offset:32992
    s_waitcnt lgkmcnt(0)
    v_sub_f32 v48, v48, v52
    v_sub_f32 v49, v49, v53
    v_sub_f32 v50, v50, v54
    v_sub_f32 v51, v51, v55
    v_add_f32 v44, v44, v48
    v_add_f32 v44, v44, v49
    v_add_f32 v44, v44, v50
    v_add_f32 v44, v44, v51

    ds_read_b128 v[48:51], v43 offset:240
    ds_read_b128 v[52:55], v45 offset:33008
    s_waitcnt lgkmcnt(0)
    v_sub_f32 v48, v48, v52
    v_sub_f32 v49, v49, v53
    v_sub_f32 v50, v50, v54
    v_sub_f32 v51, v51, v55
    v_add_f32 v44, v44, v48
    v_add_f32 v44, v44, v49
    v_add_f32 v44, v44, v50
    v_add_f32 v44, v44, v51

    v_mul_f32 v44, 0x3c800000, v44
    ds_write_b32 v40, v44 offset:33280
    s_branch p_kernel_p3

p_kernel_p2b:
    v_mov_b32 v45, 0
    v_mov_b32 v44, 0

    ds_read_b128 v[48:51], v45 offset:33536
    s_waitcnt lgkmcnt(0)
    v_add_f32 v44, v44, v48
    v_add_f32 v44, v44, v49
    v_add_f32 v44, v44, v50
    v_add_f32 v44, v44, v51

    ds_read_b128 v[48:51], v45 offset:33552
    s_waitcnt lgkmcnt(0)
    v_add_f32 v44, v44, v48
    v_add_f32 v44, v44, v49
    v_add_f32 v44, v44, v50
    v_add_f32 v44, v44, v51

    ds_read_b128 v[48:51], v45 offset:33568
    s_waitcnt lgkmcnt(0)
    v_add_f32 v44, v44, v48
    v_add_f32 v44, v44, v49
    v_add_f32 v44, v44, v50
    v_add_f32 v44, v44, v51

    ds_read_b128 v[48:51], v45 offset:33584
    s_waitcnt lgkmcnt(0)
    v_add_f32 v44, v44, v48
    v_add_f32 v44, v44, v49
    v_add_f32 v44, v44, v50
    v_add_f32 v44, v44, v51

    ds_read_b128 v[48:51], v45 offset:33600
    s_waitcnt lgkmcnt(0)
    v_add_f32 v44, v44, v48
    v_add_f32 v44, v44, v49
    v_add_f32 v44, v44, v50
    v_add_f32 v44, v44, v51

    ds_read_b128 v[48:51], v45 offset:33616
    s_waitcnt lgkmcnt(0)
    v_add_f32 v44, v44, v48
    v_add_f32 v44, v44, v49
    v_add_f32 v44, v44, v50
    v_add_f32 v44, v44, v51

    ds_read_b128 v[48:51], v45 offset:33632
    s_waitcnt lgkmcnt(0)
    v_add_f32 v44, v44, v48
    v_add_f32 v44, v44, v49
    v_add_f32 v44, v44, v50
    v_add_f32 v44, v44, v51

    ds_read_b128 v[48:51], v45 offset:33648
    s_waitcnt lgkmcnt(0)
    v_add_f32 v44, v44, v48
    v_add_f32 v44, v44, v49
    v_add_f32 v44, v44, v50
    v_add_f32 v44, v44, v51

    ds_read_b128 v[48:51], v45 offset:33664
    s_waitcnt lgkmcnt(0)
    v_add_f32 v44, v44, v48
    v_add_f32 v44, v44, v49
    v_add_f32 v44, v44, v50
    v_add_f32 v44, v44, v51

    ds_read_b128 v[48:51], v45 offset:33680
    s_waitcnt lgkmcnt(0)
    v_add_f32 v44, v44, v48
    v_add_f32 v44, v44, v49
    v_add_f32 v44, v44, v50
    v_add_f32 v44, v44, v51

    ds_read_b128 v[48:51], v45 offset:33696
    s_waitcnt lgkmcnt(0)
    v_add_f32 v44, v44, v48
    v_add_f32 v44, v44, v49
    v_add_f32 v44, v44, v50
    v_add_f32 v44, v44, v51

    ds_read_b128 v[48:51], v45 offset:33712
    s_waitcnt lgkmcnt(0)
    v_add_f32 v44, v44, v48
    v_add_f32 v44, v44, v49
    v_add_f32 v44, v44, v50
    v_add_f32 v44, v44, v51

    ds_read_b128 v[48:51], v45 offset:33728
    s_waitcnt lgkmcnt(0)
    v_add_f32 v44, v44, v48
    v_add_f32 v44, v44, v49
    v_add_f32 v44, v44, v50
    v_add_f32 v44, v44, v51

    ds_read_b128 v[48:51], v45 offset:33744
    s_waitcnt lgkmcnt(0)
    v_add_f32 v44, v44, v48
    v_add_f32 v44, v44, v49
    v_add_f32 v44, v44, v50
    v_add_f32 v44, v44, v51

    ds_read_b128 v[48:51], v45 offset:33760
    s_waitcnt lgkmcnt(0)
    v_add_f32 v44, v44, v48
    v_add_f32 v44, v44, v49
    v_add_f32 v44, v44, v50
    v_add_f32 v44, v44, v51

    ds_read_b128 v[48:51], v45 offset:33776
    s_waitcnt lgkmcnt(0)
    v_add_f32 v44, v44, v48
    v_add_f32 v44, v44, v49
    v_add_f32 v44, v44, v50
    v_add_f32 v44, v44, v51

    v_mul_f32 v44, 0x3c800000, v44
    ds_write_b32 v40, v44 offset:33792

p_kernel_p3:
    s_waitcnt lgkmcnt(0)
    s_barrier
    s_and_b32 s50, s3, 7
    s_lshr_b32 s51, s50, 1
    s_and_b32 s52, s50, 1
    s_lshr_b32 s53, s51, 1
    s_and_b32 s54, s51, 1
    v_lshlrev_b32 v43, 4, v0
    s_lshl_b32 s55, s3, 10
    s_add_u32 s55, s55, 12582912
    s_cmp_gt_u32 s3, 7
    s_cbranch_scc1 p_kernel_p4
    v_lshrrev_b32 v44, 2, v3
    v_lshlrev_b32 v44, 3, v44
    v_and_b32 v45, 3, v3
    v_lshl_add_u32 v44, v45, 1, v44
    s_lshl_b32 s56, s53, 5
    s_add_u32 s56, s56, s54
    v_add_u32 v44, s56, v44
    v_lshlrev_b32 v45, 3, v2
    s_lshl_b32 s56, s52, 5
    v_add_u32 v45, s56, v45
    v_lshlrev_b32 v46, 8, v44
    v_lshl_add_u32 v46, v45, 2, v46
    v_lshlrev_b32 v47, 2, v45
    v_lshlrev_b32 v44, 2, v44
    ds_read_b128 v[48:51], v46 offset:0
    ds_read_b128 v[52:55], v46 offset:16
    ds_read_b128 v[56:59], v47 offset:32768
    ds_read_b128 v[60:63], v47 offset:32784
    ds_read_b32 v64, v44 offset:33280
    s_waitcnt lgkmcnt(0)

    v_sub_f32 v48, v48, v56
    v_sub_f32 v48, v48, v64
    v_mul_f32 v48, 0x3e38aa3b, v48

    v_sub_f32 v49, v49, v57
    v_sub_f32 v49, v49, v64
    v_mul_f32 v49, 0x3e38aa3b, v49

    v_sub_f32 v50, v50, v58
    v_sub_f32 v50, v50, v64
    v_mul_f32 v50, 0x3e38aa3b, v50

    v_sub_f32 v51, v51, v59
    v_sub_f32 v51, v51, v64
    v_mul_f32 v51, 0x3e38aa3b, v51

    v_sub_f32 v52, v52, v60
    v_sub_f32 v52, v52, v64
    v_mul_f32 v52, 0x3e38aa3b, v52

    v_sub_f32 v53, v53, v61
    v_sub_f32 v53, v53, v64
    v_mul_f32 v53, 0x3e38aa3b, v53

    v_sub_f32 v54, v54, v62
    v_sub_f32 v54, v54, v64
    v_mul_f32 v54, 0x3e38aa3b, v54

    v_sub_f32 v55, v55, v63
    v_sub_f32 v55, v55, v64
    v_mul_f32 v55, 0x3e38aa3b, v55

    v_cvt_pk_bf16_f32 v68, v48, v50
    v_cvt_pk_bf16_f32 v69, v52, v54
    v_cvt_pk_bf16_f32 v70, v49, v51
    v_cvt_pk_bf16_f32 v71, v53, v55
    buffer_store_dwordx4 v[68:71], v43, s[32:35], s55 offen sc1
    s_cmp_gt_u32 s3, 1
    s_cbranch_scc1 p_kernel_prepdone
    v_lshlrev_b32 v45, 3, v2
    s_lshl_b32 s56, s3, 5
    v_add_u32 v45, s56, v45
    v_lshlrev_b32 v45, 2, v45
    v_mov_b32 v47, 0
    ds_read_b128 v[48:51], v45 offset:33536
    ds_read_b128 v[52:55], v45 offset:33552
    ds_read_b32 v64, v47 offset:33792
    v_and_b32 v65, 3, v3
    s_waitcnt lgkmcnt(0)

    v_sub_f32 v48, v48, v64
    v_sub_f32 v49, v49, v64
    v_sub_f32 v50, v50, v64
    v_sub_f32 v51, v51, v64
    v_sub_f32 v52, v52, v64
    v_sub_f32 v53, v53, v64
    v_sub_f32 v54, v54, v64
    v_sub_f32 v55, v55, v64
    v_cvt_pk_bf16_f32 v68, v48, v49
    v_lshlrev_b32 v66, 16, v68
    v_and_b32 v67, 0xffff0000, v68
    v_sub_f32 v66, v48, v66
    v_sub_f32 v67, v49, v67
    v_cvt_pk_bf16_f32 v72, v66, v67
    v_mov_b32 v76, 0x3f803f80
    v_cmp_eq_u32 vcc, 1, v65
    s_nop 1
    v_cndmask_b32 v76, v76, v68, vcc
    v_cmp_eq_u32 vcc, 2, v65
    s_nop 1
    v_cndmask_b32 v76, v76, v72, vcc
    v_cmp_eq_u32 vcc, 3, v65
    s_nop 1
    v_cndmask_b32 v76, v76, 0, vcc

    v_cvt_pk_bf16_f32 v69, v50, v51
    v_lshlrev_b32 v66, 16, v69
    v_and_b32 v67, 0xffff0000, v69
    v_sub_f32 v66, v50, v66
    v_sub_f32 v67, v51, v67
    v_cvt_pk_bf16_f32 v73, v66, v67
    v_mov_b32 v77, 0x3f803f80
    v_cmp_eq_u32 vcc, 1, v65
    s_nop 1
    v_cndmask_b32 v77, v77, v69, vcc
    v_cmp_eq_u32 vcc, 2, v65
    s_nop 1
    v_cndmask_b32 v77, v77, v73, vcc
    v_cmp_eq_u32 vcc, 3, v65
    s_nop 1
    v_cndmask_b32 v77, v77, 0, vcc

    v_cvt_pk_bf16_f32 v70, v52, v53
    v_lshlrev_b32 v66, 16, v70
    v_and_b32 v67, 0xffff0000, v70
    v_sub_f32 v66, v52, v66
    v_sub_f32 v67, v53, v67
    v_cvt_pk_bf16_f32 v74, v66, v67
    v_mov_b32 v78, 0x3f803f80
    v_cmp_eq_u32 vcc, 1, v65
    s_nop 1
    v_cndmask_b32 v78, v78, v70, vcc
    v_cmp_eq_u32 vcc, 2, v65
    s_nop 1
    v_cndmask_b32 v78, v78, v74, vcc
    v_cmp_eq_u32 vcc, 3, v65
    s_nop 1
    v_cndmask_b32 v78, v78, 0, vcc

    v_cvt_pk_bf16_f32 v71, v54, v55
    v_lshlrev_b32 v66, 16, v71
    v_and_b32 v67, 0xffff0000, v71
    v_sub_f32 v66, v54, v66
    v_sub_f32 v67, v55, v67
    v_cvt_pk_bf16_f32 v75, v66, v67
    v_mov_b32 v79, 0x3f803f80
    v_cmp_eq_u32 vcc, 1, v65
    s_nop 1
    v_cndmask_b32 v79, v79, v71, vcc
    v_cmp_eq_u32 vcc, 2, v65
    s_nop 1
    v_cndmask_b32 v79, v79, v75, vcc
    v_cmp_eq_u32 vcc, 3, v65
    s_nop 1
    v_cndmask_b32 v79, v79, 0, vcc

    s_lshl_b32 s55, s3, 10
    s_add_u32 s55, s55, 12599296
    buffer_store_dwordx4 v[76:79], v43, s[32:35], s55 offen sc1
    s_branch p_kernel_prepdone

p_kernel_p4:
    v_lshlrev_b32 v44, 1, v3
    s_lshl_b32 s56, s53, 5
    s_add_u32 s56, s56, s54
    v_add_u32 v44, s56, v44
    v_lshlrev_b32 v45, 3, v2
    s_lshl_b32 s56, s52, 5
    v_add_u32 v45, s56, v45
    v_lshlrev_b32 v46, 8, v45
    v_lshl_add_u32 v46, v44, 2, v46
    v_lshlrev_b32 v44, 2, v44

    ds_read_b32 v48, v46 offset:16384
    ds_read_b32 v49, v46 offset:16640
    ds_read_b32 v50, v46 offset:16896
    ds_read_b32 v51, v46 offset:17152
    ds_read_b32 v52, v46 offset:17408
    ds_read_b32 v53, v46 offset:17664
    ds_read_b32 v54, v46 offset:17920
    ds_read_b32 v55, v46 offset:18176
    ds_read_b32 v64, v44 offset:33024
    s_waitcnt lgkmcnt(0)

    v_sub_f32 v48, v48, v64
    v_sub_f32 v49, v49, v64
    v_sub_f32 v50, v50, v64
    v_sub_f32 v51, v51, v64
    v_sub_f32 v52, v52, v64
    v_sub_f32 v53, v53, v64
    v_sub_f32 v54, v54, v64
    v_sub_f32 v55, v55, v64
    v_cvt_pk_bf16_f32 v68, v48, v50
    v_cvt_pk_bf16_f32 v69, v52, v54
    v_cvt_pk_bf16_f32 v70, v49, v51
    v_cvt_pk_bf16_f32 v71, v53, v55
    buffer_store_dwordx4 v[68:71], v43, s[32:35], s55 offen sc1

p_kernel_prepdone:
    s_waitcnt vmcnt(0)
    s_barrier
    v_mov_b32 v1, 13639680
    v_mov_b32 v2, 1
    v_cmp_eq_u32 vcc, 0, v96
    s_and_saveexec_b64 s[56:57], vcc
    s_cbranch_execz p_kernel_end
    buffer_store_dword v2, v1, s[32:35], 0 offen sc1
    s_branch p_kernel_end

p_kernel_end:
    s_endpgm
.section .rodata,"a"
.p2align 6
.amdhsa_kernel k1_kernel
  .amdhsa_next_free_vgpr 64
  .amdhsa_next_free_sgpr 64
  .amdhsa_accum_offset 64
  .amdhsa_group_segment_fixed_size 0
  .amdhsa_kernarg_size 96
  .amdhsa_user_sgpr_count 2
  .amdhsa_user_sgpr_kernarg_segment_ptr 1
  .amdhsa_system_sgpr_workgroup_id_x 1
.end_amdhsa_kernel
.p2align 6
.amdhsa_kernel p_kernel
  .amdhsa_next_free_vgpr 128
  .amdhsa_next_free_sgpr 102
  .amdhsa_accum_offset 128
  .amdhsa_group_segment_fixed_size 0
  .amdhsa_kernarg_size 96
  .amdhsa_user_sgpr_count 2
  .amdhsa_user_sgpr_kernarg_segment_ptr 1
  .amdhsa_system_sgpr_workgroup_id_x 1
.end_amdhsa_kernel
```
